```python
import torch

def _softmax(x, axis=-1):
    return torch.softmax(x, dim=axis)
def _gelu(x):
    return torch.nn.functional.gelu(x, approximate="tanh")
def _silu(x):
    return torch.nn.functional.silu(x)
def _sigmoid(x):
    return torch.sigmoid(x)
def _layernorm(x, axis=-1, eps=1e-5):
    m = x.mean(dim=axis, keepdim=True)
    v = x.var(dim=axis, keepdim=True, unbiased=False)
    return (x - m) / torch.sqrt(v + eps)
def _scatter_add(tgt, idx, src, axis=0):
    return tgt.clone().index_add_(axis, idx, src)
def _segment_sum(src, seg, n):
    out = torch.zeros((n,) + src.shape[1:], dtype=src.dtype)
    return out.index_add_(0, seg, src)
def _pad(x, pw):
    flat = tuple(v for pair in reversed(pw) for v in pair)
    return torch.nn.functional.pad(x, flat)

kernel_name = 'recurrent_scan__gqa_block_cached__geglu_ffn__decode'

def setup_inputs():

    _w = (lambda a: (lambda t: t.to(torch.bfloat16) if t.is_floating_point() else t)(torch.as_tensor(a)))
    def _A_setup():
        B, Sq, D = 4, 1, 640
        Hq, Hkv, Sk, Dh = 32, 32, 4096, 128
        assert Hq % Hkv == 0, (Hq, Hkv)
        return {
            "x": _w((lambda *s: torch.randn(*s, dtype=torch.bfloat16) * 0.05)(B, Sq, D)),
            "k_cache": _w((lambda *s: torch.randn(*s, dtype=torch.bfloat16) * 1.6)(B, Hkv, Sk, Dh)),
            "v_cache": _w((lambda *s: torch.randn(*s, dtype=torch.bfloat16) * 0.2)(B, Hkv, Sk, Dh)),
            "wq": _w((lambda *s: torch.randn(*s, dtype=torch.bfloat16) * 1.6)(D, Hq * Dh) * (D ** -0.5)),
            "wo": _w((lambda *s: torch.randn(*s, dtype=torch.bfloat16) * 0.2)(Hq * Dh, D) * ((Hq * Dh) ** -0.5)),
        }
    _A_in = _A_setup()

    def _B_setup():
        B, S, D, F = 4, 1, 640, 1728
        return {
            "x": _w((lambda *s: torch.randn(*s, dtype=torch.bfloat16) * 0.05)(B, S, D)),
            "w_gate": _w((lambda *s: torch.randn(*s, dtype=torch.bfloat16) * 0.1)(D, F)),
            "w_up": _w((lambda *s: torch.randn(*s, dtype=torch.bfloat16) * 0.1)(D, F)),
            "w_down": _w((lambda *s: torch.randn(*s, dtype=torch.bfloat16) * 0.1)(F, D)),
        }
    _B_in = _B_setup()

    return {
        "A_x": _A_in["x"],
        "A_k_cache": _A_in["k_cache"],
        "A_v_cache": _A_in["v_cache"],
        "A_wq": _A_in["wq"],
        "A_wo": _A_in["wo"],
        "B_x": _B_in["x"],
        "B_w_gate": _B_in["w_gate"],
        "B_w_up": _B_in["w_up"],
        "B_w_down": _B_in["w_down"],
    }

def reference(A_x, A_k_cache, A_v_cache, A_wq, A_wo, B_x, B_w_gate, B_w_up, B_w_down):
    def _A_ref(x, k_cache, v_cache, wq, wo):
        B, Sq, D = x.shape
        Hq, Dh = 32, 128
        Hkv = k_cache.shape[1]
        rep = Hq // Hkv
        q = (lambda x, *d: x.permute(*d))((x @ wq).reshape(B, Sq, Hq, Dh), 0, 2, 1, 3)
        k = (lambda x, n, axis: torch.repeat_interleave(x, n, dim=axis))(k_cache, rep, axis=1)
        v = (lambda x, n, axis: torch.repeat_interleave(x, n, dim=axis))(v_cache, rep, axis=1)
        scores = torch.einsum("bhqd,bhkd->bhqk", q, k) * (Dh ** -0.5)
        p = _softmax(scores, axis=-1)
        o = torch.einsum("bhqk,bhkd->bhqd", p, v)
        return (lambda x, *d: x.permute(*d))(o, 0, 2, 1, 3).reshape(B, Sq, Hq * Dh) @ wo

    def _B_ref(x, w_gate, w_up, w_down):
        return (_gelu(x @ w_gate) * (x @ w_up)) @ w_down

    x = A_x
    xn = _layernorm(x, axis=-1)
    s = _A_ref(xn, A_k_cache, A_v_cache, A_wq, A_wo)
    g = _silu(_B_ref(xn, B_w_gate, B_w_up, B_w_down))
    return x + s * g
```

```asm
; @launch grid=(256,1,1) block=(512,1,1) lds=67584
.amdgcn_target "amdgcn-amd-amdhsa--gfx950"
.text
.globl recurrent_scan__gqa_block_cached__geglu_ffn__decode_kernel
.p2align 8
.type recurrent_scan__gqa_block_cached__geglu_ffn__decode_kernel,@function
recurrent_scan__gqa_block_cached__geglu_ffn__decode_kernel:
  s_cmp_ge_u32 s2, 256
  s_cbranch_scc1 L_end
  s_load_dwordx16 s[8:23], s[0:1], 0
  s_load_dwordx8 s[24:31], s[0:1], 64
  v_lshrrev_b32 v1, 6, v0
  v_and_b32 v0, 63, v0
  v_readfirstlane_b32 s3, v1
  s_nop 0
  s_cmp_lg_u32 s3, 0
  s_nop 1
  s_cbranch_scc1 L_noinit_1
  v_mov_b32 v2, -1
  v_cmp_gt_u32 vcc, 32, v0
  s_nop 1
  v_cndmask_b32 v2, 0, v2, vcc
  v_lshlrev_b32 v3, 2, v0
  ds_write_b32 v3, v2 offset:13312
L_noinit_1:
  s_and_b32 s64, s2, 7
  s_lshr_b32 s68, s2, 3
  s_and_b32 s69, s68, 3
  s_lshl_b32 s69, s69, 3
  s_add_u32 s64, s64, s69
  s_lshr_b32 s65, s68, 2
  s_and_b32 s65, s65, 3
  s_lshr_b32 s66, s68, 4
  s_lshl_b32 s67, s64, 1
  s_add_u32 s67, s67, s66
  s_cmp_eq_u32 s66, 1
  s_cselect_b32 s84, s64, 99
  s_waitcnt lgkmcnt(0)
  s_cmp_ge_u32 s3, 4
  s_cbranch_scc1 L_helper
  s_setprio 2
  s_mov_b32 s32, s10
  s_and_b32 s33, s11, 0xffff
  s_mov_b32 s34, 0x8000000
  s_mov_b32 s35, 0x20000
  s_mov_b32 s36, s12
  s_and_b32 s37, s13, 0xffff
  s_mov_b32 s38, 0x8000000
  s_mov_b32 s39, 0x20000
  v_lshrrev_b32 v52, 4, v0
  v_lshlrev_b32 v55, 2, v52
  v_and_b32 v54, 3, v0
  v_add_u32 v55, v55, v54
  v_lshlrev_b32 v3, 4, v55
  v_lshlrev_b32 v52, 6, v52
  v_bfe_u32 v53, v0, 2, 2
  v_lshlrev_b32 v53, 8, v53
  v_lshlrev_b32 v54, 4, v54
  v_add3_u32 v1, v52, v53, v54
  v_lshlrev_b32 v2, 4, v0
  s_lshl_b32 s40, s65, 5
  s_add_u32 s40, s40, s64
  s_lshl_b32 s40, s40, 20
  s_lshl_b32 s41, s66, 19
  s_add_u32 s40, s40, s41
  s_lshl_b32 s41, s3, 12
  s_add_u32 s40, s40, s41
  s_mov_b32 s41, s40
  buffer_load_dwordx4 v[64:67], v1, s[32:35], s41 offen offset:0 nt
  buffer_load_dwordx4 v[68:71], v1, s[32:35], s41 offen offset:1024 nt
  buffer_load_dwordx4 v[72:75], v1, s[32:35], s41 offen offset:2048 nt
  buffer_load_dwordx4 v[76:79], v1, s[32:35], s41 offen offset:3072 nt
  s_add_u32 s41, s41, 0x4000
  buffer_load_dwordx4 v[80:83], v1, s[32:35], s41 offen offset:0 nt
  s_barrier
  v_and_b32 v52, 15, v0
  v_mov_b32 v53, v52
  v_and_b32 v54, 1, v53
  v_cmp_eq_u32 vcc, 1, v54
  v_mov_b32 v54, 0xffff
  v_mov_b32 v4, 0xffff0000
  v_cndmask_b32 v54, v54, v4, vcc
  v_lshrrev_b32 v53, 1, v53
  v_cmp_eq_u32 vcc, 0, v53
  s_nop 1
  v_cndmask_b32 v4, 0, v54, vcc
  v_cmp_eq_u32 vcc, 1, v53
  s_nop 1
  v_cndmask_b32 v5, 0, v54, vcc
  v_cmp_eq_u32 vcc, 2, v53
  s_nop 1
  v_cndmask_b32 v6, 0, v54, vcc
  v_cmp_eq_u32 vcc, 3, v53
  s_nop 1
  v_cndmask_b32 v7, 0, v54, vcc
  s_mov_b32 s44, 0x22222222
  s_mov_b32 s45, 0x22222222
  s_mov_b32 s46, 0x44444444
  s_mov_b32 s47, 0x44444444
  s_mov_b32 s48, 0x88888888
  s_mov_b32 s49, 0x88888888
  s_mov_b32 s50, 0xf000f
  s_mov_b32 s51, 0xf000f
  s_mov_b32 s52, 0xf000f0
  s_mov_b32 s53, 0xf000f0
  s_mov_b32 s54, 0xf000f00
  s_mov_b32 s55, 0xf000f00
  s_mov_b32 s56, 0xf000f000
  s_mov_b32 s57, 0xf000f000
  s_waitcnt vmcnt(4)
  buffer_load_dwordx4 v[84:87], v1, s[32:35], s41 offen offset:1024 nt
  s_waitcnt vmcnt(4)
  buffer_load_dwordx4 v[88:91], v1, s[32:35], s41 offen offset:2048 nt
  s_waitcnt vmcnt(4)
  buffer_load_dwordx4 v[92:95], v1, s[32:35], s41 offen offset:3072 nt
  s_waitcnt vmcnt(4)
  s_add_u32 s41, s41, 0x4000
  buffer_load_dwordx4 v[96:99], v1, s[32:35], s41 offen offset:0 nt
  s_waitcnt vmcnt(4)
  buffer_load_dwordx4 v[100:103], v1, s[32:35], s41 offen offset:1024 nt
  s_waitcnt vmcnt(4)
  buffer_load_dwordx4 v[104:107], v1, s[32:35], s41 offen offset:2048 nt
  s_waitcnt vmcnt(4)
  buffer_load_dwordx4 v[108:111], v1, s[32:35], s41 offen offset:3072 nt
  s_waitcnt vmcnt(4)
  s_add_u32 s41, s41, 0x4000
  buffer_load_dwordx4 v[112:115], v1, s[32:35], s41 offen offset:0 nt
  s_waitcnt vmcnt(4)
  buffer_load_dwordx4 v[116:119], v1, s[32:35], s41 offen offset:1024 nt
  s_waitcnt vmcnt(4)
  buffer_load_dwordx4 v[120:123], v1, s[32:35], s41 offen offset:2048 nt
  s_waitcnt vmcnt(4)
  buffer_load_dwordx4 v[124:127], v1, s[32:35], s41 offen offset:3072 nt
  s_waitcnt vmcnt(4)
  s_add_u32 s41, s41, 0x4000
  buffer_load_dwordx4 v[128:131], v1, s[32:35], s41 offen offset:0 nt
  s_waitcnt vmcnt(4)
  buffer_load_dwordx4 v[132:135], v1, s[32:35], s41 offen offset:1024 nt
  s_waitcnt vmcnt(4)
  buffer_load_dwordx4 v[136:139], v1, s[32:35], s41 offen offset:2048 nt
  s_waitcnt vmcnt(4)
  buffer_load_dwordx4 v[140:143], v1, s[32:35], s41 offen offset:3072 nt
  s_waitcnt vmcnt(4)
  s_add_u32 s41, s41, 0x4000
  buffer_load_dwordx4 v[144:147], v1, s[32:35], s41 offen offset:0 nt
  s_waitcnt vmcnt(4)
  buffer_load_dwordx4 v[148:151], v1, s[32:35], s41 offen offset:1024 nt
  s_waitcnt vmcnt(4)
  buffer_load_dwordx4 v[152:155], v1, s[32:35], s41 offen offset:2048 nt
  s_waitcnt vmcnt(4)
  buffer_load_dwordx4 v[156:159], v1, s[32:35], s41 offen offset:3072 nt
  s_waitcnt vmcnt(4)
  s_add_u32 s41, s41, 0x4000
  buffer_load_dwordx4 v[160:163], v1, s[32:35], s41 offen offset:0 nt
  s_waitcnt vmcnt(4)
  buffer_load_dwordx4 v[164:167], v1, s[32:35], s41 offen offset:1024 nt
  s_waitcnt vmcnt(4)
  buffer_load_dwordx4 v[168:171], v1, s[32:35], s41 offen offset:2048 nt
  s_waitcnt vmcnt(4)
  buffer_load_dwordx4 v[172:175], v1, s[32:35], s41 offen offset:3072 nt
  s_waitcnt vmcnt(4)
  s_add_u32 s41, s41, 0x4000
  buffer_load_dwordx4 v[176:179], v1, s[32:35], s41 offen offset:0 nt
  s_barrier
  ds_read_b128 v[56:59], v3 offset:13568
  s_waitcnt vmcnt(4)
  buffer_load_dwordx4 v[180:183], v1, s[32:35], s41 offen offset:1024 nt
  s_waitcnt lgkmcnt(0)
  v_cndmask_b32 v8, 0, v56, s[50:51]
  v_cndmask_b32 v9, 0, v57, s[50:51]
  v_cndmask_b32 v10, 0, v58, s[50:51]
  v_cndmask_b32 v11, 0, v59, s[50:51]
  v_cndmask_b32 v12, 0, v56, s[52:53]
  v_cndmask_b32 v13, 0, v57, s[52:53]
  v_cndmask_b32 v14, 0, v58, s[52:53]
  v_cndmask_b32 v15, 0, v59, s[52:53]
  v_cndmask_b32 v16, 0, v56, s[54:55]
  v_cndmask_b32 v17, 0, v57, s[54:55]
  v_cndmask_b32 v18, 0, v58, s[54:55]
  v_cndmask_b32 v19, 0, v59, s[54:55]
  v_cndmask_b32 v20, 0, v56, s[56:57]
  v_cndmask_b32 v21, 0, v57, s[56:57]
  v_cndmask_b32 v22, 0, v58, s[56:57]
  v_cndmask_b32 v23, 0, v59, s[56:57]
  s_cmp_lt_u32 s3, 0
  s_cselect_b32 s59, 1, 0
  s_and_b32 s58, s2, 7
  s_lshl_b32 s60, s65, 3
  s_add_u32 s58, s58, s60
  s_cmp_lt_u32 s58, 27
  s_cselect_b32 s58, 1, 0
  s_cmp_eq_u32 s66, 0
  s_cselect_b32 s58, s58, 0
  s_or_b32 s58, s58, s59
  v_mfma_f32_16x16x32_bf16 v[24:27], v[64:67], v[8:11], 0
  v_mfma_f32_16x16x32_bf16 v[24:27], v[68:71], v[12:15], v[24:27]
  v_mfma_f32_16x16x32_bf16 v[24:27], v[72:75], v[16:19], v[24:27]
  v_mfma_f32_16x16x32_bf16 v[24:27], v[76:79], v[20:23], v[24:27]
  v_mfma_f32_16x16x32_bf16 v[28:31], v[80:83], v[8:11], 0
  v_mfma_f32_16x16x32_bf16 v[28:31], v[84:87], v[12:15], v[28:31]
  s_nop 5
  v_cndmask_b32 v52, v24, v25, s[44:45]
  v_cndmask_b32 v52, v52, v26, s[46:47]
  v_cndmask_b32 v52, v52, v27, s[48:49]
  s_nop 1
  v_add_f32_dpp v52, v52, v52 quad_perm:[1,0,3,2] row_mask:0xf bank_mask:0xf
  s_nop 1
  v_add_f32_dpp v32, v52, v52 quad_perm:[2,3,0,1] row_mask:0xf bank_mask:0xf
  v_mfma_f32_16x16x32_bf16 v[28:31], v[88:91], v[16:19], v[28:31]
  s_waitcnt vmcnt(5)
  s_cmp_eq_u32 s58, 1
  s_nop 4
  s_cbranch_scc1 L_bo_2
  s_waitcnt vmcnt(4)
L_bo_2:
  buffer_load_dwordx4 v[184:187], v1, s[32:35], s41 offen offset:2048 nt
  v_mfma_f32_16x16x32_bf16 v[28:31], v[92:95], v[20:23], v[28:31]
  v_mfma_f32_16x16x32_bf16 v[24:27], v[96:99], v[8:11], 0
  v_mfma_f32_16x16x32_bf16 v[24:27], v[100:103], v[12:15], v[24:27]
  s_nop 5
  v_cndmask_b32 v52, v28, v29, s[44:45]
  v_cndmask_b32 v52, v52, v30, s[46:47]
  v_cndmask_b32 v52, v52, v31, s[48:49]
  s_nop 1
  v_add_f32_dpp v52, v52, v52 quad_perm:[1,0,3,2] row_mask:0xf bank_mask:0xf
  s_nop 1
  v_add_f32_dpp v52, v52, v52 quad_perm:[2,3,0,1] row_mask:0xf bank_mask:0xf
  v_cndmask_b32 v32, v32, v52, s[44:45]
  v_mfma_f32_16x16x32_bf16 v[24:27], v[104:107], v[16:19], v[24:27]
  v_mfma_f32_16x16x32_bf16 v[24:27], v[108:111], v[20:23], v[24:27]
  v_mfma_f32_16x16x32_bf16 v[28:31], v[112:115], v[8:11], 0
  v_mfma_f32_16x16x32_bf16 v[28:31], v[116:119], v[12:15], v[28:31]
  s_nop 5
  v_cndmask_b32 v52, v24, v25, s[44:45]
  v_cndmask_b32 v52, v52, v26, s[46:47]
  v_cndmask_b32 v52, v52, v27, s[48:49]
  s_nop 1
  v_add_f32_dpp v52, v52, v52 quad_perm:[1,0,3,2] row_mask:0xf bank_mask:0xf
  s_nop 1
  v_add_f32_dpp v52, v52, v52 quad_perm:[2,3,0,1] row_mask:0xf bank_mask:0xf
  v_cndmask_b32 v32, v32, v52, s[46:47]
  v_mfma_f32_16x16x32_bf16 v[28:31], v[120:123], v[16:19], v[28:31]
  s_waitcnt vmcnt(5)
  s_cmp_eq_u32 s58, 1
  s_nop 4
  s_cbranch_scc1 L_bo_3
  s_waitcnt vmcnt(4)
L_bo_3:
  buffer_load_dwordx4 v[188:191], v1, s[32:35], s41 offen offset:3072 nt
  v_mfma_f32_16x16x32_bf16 v[28:31], v[124:127], v[20:23], v[28:31]
  v_mfma_f32_16x16x32_bf16 v[24:27], v[128:131], v[8:11], 0
  v_mfma_f32_16x16x32_bf16 v[24:27], v[132:135], v[12:15], v[24:27]
  s_nop 5
  v_cndmask_b32 v52, v28, v29, s[44:45]
  v_cndmask_b32 v52, v52, v30, s[46:47]
  v_cndmask_b32 v52, v52, v31, s[48:49]
  s_nop 1
  v_add_f32_dpp v52, v52, v52 quad_perm:[1,0,3,2] row_mask:0xf bank_mask:0xf
  s_nop 1
  v_add_f32_dpp v52, v52, v52 quad_perm:[2,3,0,1] row_mask:0xf bank_mask:0xf
  v_cndmask_b32 v32, v32, v52, s[48:49]
  v_mfma_f32_16x16x32_bf16 v[24:27], v[136:139], v[16:19], v[24:27]
  v_mfma_f32_16x16x32_bf16 v[24:27], v[140:143], v[20:23], v[24:27]
  v_mfma_f32_16x16x32_bf16 v[28:31], v[144:147], v[8:11], 0
  v_mfma_f32_16x16x32_bf16 v[28:31], v[148:151], v[12:15], v[28:31]
  s_nop 5
  v_cndmask_b32 v52, v24, v25, s[44:45]
  v_cndmask_b32 v52, v52, v26, s[46:47]
  v_cndmask_b32 v52, v52, v27, s[48:49]
  s_nop 1
  v_add_f32_dpp v52, v52, v52 quad_perm:[1,0,3,2] row_mask:0xf bank_mask:0xf
  s_nop 1
  v_add_f32_dpp v33, v52, v52 quad_perm:[2,3,0,1] row_mask:0xf bank_mask:0xf
  v_mfma_f32_16x16x32_bf16 v[28:31], v[152:155], v[16:19], v[28:31]
  s_waitcnt vmcnt(5)
  s_cmp_eq_u32 s58, 1
  s_nop 4
  s_cbranch_scc1 L_bo_4
  s_waitcnt vmcnt(4)
L_bo_4:
  s_add_u32 s41, s41, 0x4000
  buffer_load_dwordx4 v[192:195], v1, s[32:35], s41 offen offset:0 nt
  v_mfma_f32_16x16x32_bf16 v[28:31], v[156:159], v[20:23], v[28:31]
  v_mfma_f32_16x16x32_bf16 v[24:27], v[160:163], v[8:11], 0
  v_mfma_f32_16x16x32_bf16 v[24:27], v[164:167], v[12:15], v[24:27]
  s_nop 5
  v_cndmask_b32 v52, v28, v29, s[44:45]
  v_cndmask_b32 v52, v52, v30, s[46:47]
  v_cndmask_b32 v52, v52, v31, s[48:49]
  s_nop 1
  v_add_f32_dpp v52, v52, v52 quad_perm:[1,0,3,2] row_mask:0xf bank_mask:0xf
  s_nop 1
  v_add_f32_dpp v52, v52, v52 quad_perm:[2,3,0,1] row_mask:0xf bank_mask:0xf
  v_cndmask_b32 v33, v33, v52, s[44:45]
  v_mfma_f32_16x16x32_bf16 v[24:27], v[168:171], v[16:19], v[24:27]
  s_waitcnt vmcnt(5)
  s_cmp_eq_u32 s58, 1
  s_nop 4
  s_cbranch_scc1 L_bo_5
  s_waitcnt vmcnt(4)
L_bo_5:
  buffer_load_dwordx4 v[196:199], v1, s[32:35], s41 offen offset:1024 nt
  v_mfma_f32_16x16x32_bf16 v[24:27], v[172:175], v[20:23], v[24:27]
  s_waitcnt vmcnt(5)
  s_cmp_eq_u32 s58, 1
  s_nop 4
  s_cbranch_scc1 L_bo_6
  s_waitcnt vmcnt(4)
L_bo_6:
  buffer_load_dwordx4 v[200:203], v1, s[32:35], s41 offen offset:2048 nt
  v_mfma_f32_16x16x32_bf16 v[28:31], v[176:179], v[8:11], 0
  s_waitcnt vmcnt(5)
  s_cmp_eq_u32 s58, 1
  s_nop 4
  s_cbranch_scc1 L_bo_7
  s_waitcnt vmcnt(4)
L_bo_7:
  buffer_load_dwordx4 v[204:207], v1, s[32:35], s41 offen offset:3072 nt
  v_mfma_f32_16x16x32_bf16 v[28:31], v[180:183], v[12:15], v[28:31]
  v_cndmask_b32 v52, v24, v25, s[44:45]
  v_cndmask_b32 v52, v52, v26, s[46:47]
  v_cndmask_b32 v52, v52, v27, s[48:49]
  s_nop 1
  v_add_f32_dpp v52, v52, v52 quad_perm:[1,0,3,2] row_mask:0xf bank_mask:0xf
  s_nop 1
  v_add_f32_dpp v52, v52, v52 quad_perm:[2,3,0,1] row_mask:0xf bank_mask:0xf
  v_cndmask_b32 v33, v33, v52, s[46:47]
  s_waitcnt vmcnt(5)
  s_cmp_eq_u32 s58, 1
  s_cbranch_scc1 L_bo_8
  s_waitcnt vmcnt(4)
L_bo_8:
  s_add_u32 s41, s41, 0x4000
  buffer_load_dwordx4 v[208:211], v1, s[32:35], s41 offen offset:0 nt
  v_mfma_f32_16x16x32_bf16 v[28:31], v[184:187], v[16:19], v[28:31]
  s_waitcnt vmcnt(5)
  s_cmp_eq_u32 s58, 1
  s_nop 4
  s_cbranch_scc1 L_bo_9
  s_waitcnt vmcnt(4)
L_bo_9:
  buffer_load_dwordx4 v[212:215], v1, s[32:35], s41 offen offset:1024 nt
  v_mfma_f32_16x16x32_bf16 v[28:31], v[188:191], v[20:23], v[28:31]
  s_waitcnt vmcnt(5)
  s_cmp_eq_u32 s58, 1
  s_nop 4
  s_cbranch_scc1 L_bo_10
  s_waitcnt vmcnt(4)
L_bo_10:
  buffer_load_dwordx4 v[216:219], v1, s[32:35], s41 offen offset:2048 nt
  v_mfma_f32_16x16x32_bf16 v[24:27], v[192:195], v[8:11], 0
  s_waitcnt vmcnt(5)
  s_cmp_eq_u32 s58, 1
  s_nop 4
  s_cbranch_scc1 L_bo_11
  s_waitcnt vmcnt(4)
L_bo_11:
  buffer_load_dwordx4 v[220:223], v1, s[32:35], s41 offen offset:3072 nt
  v_mfma_f32_16x16x32_bf16 v[24:27], v[196:199], v[12:15], v[24:27]
  v_cndmask_b32 v52, v28, v29, s[44:45]
  v_cndmask_b32 v52, v52, v30, s[46:47]
  v_cndmask_b32 v52, v52, v31, s[48:49]
  s_nop 1
  v_add_f32_dpp v52, v52, v52 quad_perm:[1,0,3,2] row_mask:0xf bank_mask:0xf
  s_nop 1
  v_add_f32_dpp v52, v52, v52 quad_perm:[2,3,0,1] row_mask:0xf bank_mask:0xf
  v_cndmask_b32 v33, v33, v52, s[48:49]
  s_waitcnt vmcnt(5)
  s_cmp_eq_u32 s58, 1
  s_cbranch_scc1 L_bo_12
  s_waitcnt vmcnt(4)
L_bo_12:
  s_add_u32 s41, s41, 0x4000
  buffer_load_dwordx4 v[64:67], v1, s[32:35], s41 offen offset:0 nt
  v_mfma_f32_16x16x32_bf16 v[24:27], v[200:203], v[16:19], v[24:27]
  s_waitcnt vmcnt(5)
  s_cmp_eq_u32 s58, 1
  s_nop 4
  s_cbranch_scc1 L_bo_13
  s_waitcnt vmcnt(4)
L_bo_13:
  buffer_load_dwordx4 v[68:71], v1, s[32:35], s41 offen offset:1024 nt
  v_mfma_f32_16x16x32_bf16 v[24:27], v[204:207], v[20:23], v[24:27]
  s_waitcnt vmcnt(5)
  s_cmp_eq_u32 s58, 1
  s_nop 4
  s_cbranch_scc1 L_bo_14
  s_waitcnt vmcnt(4)
L_bo_14:
  buffer_load_dwordx4 v[72:75], v1, s[32:35], s41 offen offset:2048 nt
  v_mfma_f32_16x16x32_bf16 v[28:31], v[208:211], v[8:11], 0
  s_waitcnt vmcnt(5)
  s_cmp_eq_u32 s58, 1
  s_nop 4
  s_cbranch_scc1 L_bo_15
  s_waitcnt vmcnt(4)
L_bo_15:
  buffer_load_dwordx4 v[76:79], v1, s[32:35], s41 offen offset:3072 nt
  v_mfma_f32_16x16x32_bf16 v[28:31], v[212:215], v[12:15], v[28:31]
  v_cndmask_b32 v52, v24, v25, s[44:45]
  v_cndmask_b32 v52, v52, v26, s[46:47]
  v_cndmask_b32 v52, v52, v27, s[48:49]
  s_nop 1
  v_add_f32_dpp v52, v52, v52 quad_perm:[1,0,3,2] row_mask:0xf bank_mask:0xf
  s_nop 1
  v_add_f32_dpp v34, v52, v52 quad_perm:[2,3,0,1] row_mask:0xf bank_mask:0xf
  s_waitcnt vmcnt(5)
  s_cmp_eq_u32 s58, 1
  s_cbranch_scc1 L_bo_16
  s_waitcnt vmcnt(4)
L_bo_16:
  s_add_u32 s41, s41, 0x4000
  buffer_load_dwordx4 v[80:83], v1, s[32:35], s41 offen offset:0 nt
  v_mfma_f32_16x16x32_bf16 v[28:31], v[216:219], v[16:19], v[28:31]
  s_waitcnt vmcnt(5)
  s_cmp_eq_u32 s58, 1
  s_nop 4
  s_cbranch_scc1 L_bo_17
  s_waitcnt vmcnt(4)
L_bo_17:
  buffer_load_dwordx4 v[84:87], v1, s[32:35], s41 offen offset:1024 nt
  v_mfma_f32_16x16x32_bf16 v[28:31], v[220:223], v[20:23], v[28:31]
  s_waitcnt vmcnt(5)
  s_cmp_eq_u32 s58, 1
  s_nop 4
  s_cbranch_scc1 L_bo_18
  s_waitcnt vmcnt(4)
L_bo_18:
  buffer_load_dwordx4 v[88:91], v1, s[32:35], s41 offen offset:2048 nt
  v_mfma_f32_16x16x32_bf16 v[24:27], v[64:67], v[8:11], 0
  s_waitcnt vmcnt(5)
  s_cmp_eq_u32 s58, 1
  s_nop 4
  s_cbranch_scc1 L_bo_19
  s_waitcnt vmcnt(4)
L_bo_19:
  buffer_load_dwordx4 v[92:95], v1, s[32:35], s41 offen offset:3072 nt
  v_mfma_f32_16x16x32_bf16 v[24:27], v[68:71], v[12:15], v[24:27]
  v_cndmask_b32 v52, v28, v29, s[44:45]
  v_cndmask_b32 v52, v52, v30, s[46:47]
  v_cndmask_b32 v52, v52, v31, s[48:49]
  s_nop 1
  v_add_f32_dpp v52, v52, v52 quad_perm:[1,0,3,2] row_mask:0xf bank_mask:0xf
  s_nop 1
  v_add_f32_dpp v52, v52, v52 quad_perm:[2,3,0,1] row_mask:0xf bank_mask:0xf
  v_cndmask_b32 v34, v34, v52, s[44:45]
  s_waitcnt vmcnt(5)
  s_cmp_eq_u32 s58, 1
  s_cbranch_scc1 L_bo_20
  s_waitcnt vmcnt(4)
L_bo_20:
  s_add_u32 s41, s41, 0x4000
  buffer_load_dwordx4 v[96:99], v1, s[32:35], s41 offen offset:0 nt
  v_mfma_f32_16x16x32_bf16 v[24:27], v[72:75], v[16:19], v[24:27]
  s_waitcnt vmcnt(5)
  s_cmp_eq_u32 s58, 1
  s_nop 4
  s_cbranch_scc1 L_bo_21
  s_waitcnt vmcnt(4)
L_bo_21:
  buffer_load_dwordx4 v[100:103], v1, s[32:35], s41 offen offset:1024 nt
  v_mfma_f32_16x16x32_bf16 v[24:27], v[76:79], v[20:23], v[24:27]
  s_waitcnt vmcnt(5)
  s_cmp_eq_u32 s58, 1
  s_nop 4
  s_cbranch_scc1 L_bo_22
  s_waitcnt vmcnt(4)
L_bo_22:
  buffer_load_dwordx4 v[104:107], v1, s[32:35], s41 offen offset:2048 nt
  v_mfma_f32_16x16x32_bf16 v[28:31], v[80:83], v[8:11], 0
  s_waitcnt vmcnt(5)
  s_cmp_eq_u32 s58, 1
  s_nop 4
  s_cbranch_scc1 L_bo_23
  s_waitcnt vmcnt(4)
L_bo_23:
  buffer_load_dwordx4 v[108:111], v1, s[32:35], s41 offen offset:3072 nt
  v_mfma_f32_16x16x32_bf16 v[28:31], v[84:87], v[12:15], v[28:31]
  v_cndmask_b32 v52, v24, v25, s[44:45]
  v_cndmask_b32 v52, v52, v26, s[46:47]
  v_cndmask_b32 v52, v52, v27, s[48:49]
  s_nop 1
  v_add_f32_dpp v52, v52, v52 quad_perm:[1,0,3,2] row_mask:0xf bank_mask:0xf
  s_nop 1
  v_add_f32_dpp v52, v52, v52 quad_perm:[2,3,0,1] row_mask:0xf bank_mask:0xf
  v_cndmask_b32 v34, v34, v52, s[46:47]
  s_waitcnt vmcnt(5)
  s_cmp_eq_u32 s58, 1
  s_cbranch_scc1 L_bo_24
  s_waitcnt vmcnt(4)
L_bo_24:
  s_add_u32 s41, s41, 0x4000
  buffer_load_dwordx4 v[112:115], v1, s[32:35], s41 offen offset:0 nt
  v_mfma_f32_16x16x32_bf16 v[28:31], v[88:91], v[16:19], v[28:31]
  s_waitcnt vmcnt(5)
  s_cmp_eq_u32 s58, 1
  s_nop 4
  s_cbranch_scc1 L_bo_25
  s_waitcnt vmcnt(4)
L_bo_25:
  buffer_load_dwordx4 v[116:119], v1, s[32:35], s41 offen offset:1024 nt
  v_mfma_f32_16x16x32_bf16 v[28:31], v[92:95], v[20:23], v[28:31]
  s_waitcnt vmcnt(5)
  s_cmp_eq_u32 s58, 1
  s_nop 4
  s_cbranch_scc1 L_bo_26
  s_waitcnt vmcnt(4)
L_bo_26:
  buffer_load_dwordx4 v[120:123], v1, s[32:35], s41 offen offset:2048 nt
  v_mfma_f32_16x16x32_bf16 v[24:27], v[96:99], v[8:11], 0
  s_waitcnt vmcnt(5)
  s_cmp_eq_u32 s58, 1
  s_nop 4
  s_cbranch_scc1 L_bo_27
  s_waitcnt vmcnt(4)
L_bo_27:
  buffer_load_dwordx4 v[124:127], v1, s[32:35], s41 offen offset:3072 nt
  v_mfma_f32_16x16x32_bf16 v[24:27], v[100:103], v[12:15], v[24:27]
  v_cndmask_b32 v52, v28, v29, s[44:45]
  v_cndmask_b32 v52, v52, v30, s[46:47]
  v_cndmask_b32 v52, v52, v31, s[48:49]
  s_nop 1
  v_add_f32_dpp v52, v52, v52 quad_perm:[1,0,3,2] row_mask:0xf bank_mask:0xf
  s_nop 1
  v_add_f32_dpp v52, v52, v52 quad_perm:[2,3,0,1] row_mask:0xf bank_mask:0xf
  v_cndmask_b32 v34, v34, v52, s[48:49]
  s_waitcnt vmcnt(5)
  s_cmp_eq_u32 s58, 1
  s_cbranch_scc1 L_bo_28
  s_waitcnt vmcnt(4)
L_bo_28:
  s_add_u32 s41, s41, 0x4000
  buffer_load_dwordx4 v[128:131], v1, s[32:35], s41 offen offset:0 nt
  v_mfma_f32_16x16x32_bf16 v[24:27], v[104:107], v[16:19], v[24:27]
  s_waitcnt vmcnt(5)
  s_cmp_eq_u32 s58, 1
  s_nop 4
  s_cbranch_scc1 L_bo_29
  s_waitcnt vmcnt(4)
L_bo_29:
  buffer_load_dwordx4 v[132:135], v1, s[32:35], s41 offen offset:1024 nt
  v_mfma_f32_16x16x32_bf16 v[24:27], v[108:111], v[20:23], v[24:27]
  s_waitcnt vmcnt(5)
  s_cmp_eq_u32 s58, 1
  s_nop 4
  s_cbranch_scc1 L_bo_30
  s_waitcnt vmcnt(4)
L_bo_30:
  buffer_load_dwordx4 v[136:139], v1, s[32:35], s41 offen offset:2048 nt
  v_mfma_f32_16x16x32_bf16 v[28:31], v[112:115], v[8:11], 0
  s_waitcnt vmcnt(5)
  s_cmp_eq_u32 s58, 1
  s_nop 4
  s_cbranch_scc1 L_bo_31
  s_waitcnt vmcnt(4)
L_bo_31:
  buffer_load_dwordx4 v[140:143], v1, s[32:35], s41 offen offset:3072 nt
  v_mfma_f32_16x16x32_bf16 v[28:31], v[116:119], v[12:15], v[28:31]
  v_cndmask_b32 v52, v24, v25, s[44:45]
  v_cndmask_b32 v52, v52, v26, s[46:47]
  v_cndmask_b32 v52, v52, v27, s[48:49]
  s_nop 1
  v_add_f32_dpp v52, v52, v52 quad_perm:[1,0,3,2] row_mask:0xf bank_mask:0xf
  s_nop 1
  v_add_f32_dpp v35, v52, v52 quad_perm:[2,3,0,1] row_mask:0xf bank_mask:0xf
  s_waitcnt vmcnt(5)
  s_cmp_eq_u32 s58, 1
  s_cbranch_scc1 L_bo_32
  s_waitcnt vmcnt(4)
L_bo_32:
  s_add_u32 s41, s41, 0x4000
  buffer_load_dwordx4 v[144:147], v1, s[32:35], s41 offen offset:0 nt
  v_mfma_f32_16x16x32_bf16 v[28:31], v[120:123], v[16:19], v[28:31]
  s_waitcnt vmcnt(5)
  s_cmp_eq_u32 s58, 1
  s_nop 4
  s_cbranch_scc1 L_bo_33
  s_waitcnt vmcnt(4)
L_bo_33:
  buffer_load_dwordx4 v[148:151], v1, s[32:35], s41 offen offset:1024 nt
  v_mfma_f32_16x16x32_bf16 v[28:31], v[124:127], v[20:23], v[28:31]
  s_waitcnt vmcnt(5)
  s_cmp_eq_u32 s58, 1
  s_nop 4
  s_cbranch_scc1 L_bo_34
  s_waitcnt vmcnt(4)
L_bo_34:
  buffer_load_dwordx4 v[152:155], v1, s[32:35], s41 offen offset:2048 nt
  v_mfma_f32_16x16x32_bf16 v[24:27], v[128:131], v[8:11], 0
  s_waitcnt vmcnt(5)
  s_cmp_eq_u32 s58, 1
  s_nop 4
  s_cbranch_scc1 L_bo_35
  s_waitcnt vmcnt(4)
L_bo_35:
  buffer_load_dwordx4 v[156:159], v1, s[32:35], s41 offen offset:3072 nt
  v_mfma_f32_16x16x32_bf16 v[24:27], v[132:135], v[12:15], v[24:27]
  v_cndmask_b32 v52, v28, v29, s[44:45]
  v_cndmask_b32 v52, v52, v30, s[46:47]
  v_cndmask_b32 v52, v52, v31, s[48:49]
  s_nop 1
  v_add_f32_dpp v52, v52, v52 quad_perm:[1,0,3,2] row_mask:0xf bank_mask:0xf
  s_nop 1
  v_add_f32_dpp v52, v52, v52 quad_perm:[2,3,0,1] row_mask:0xf bank_mask:0xf
  v_cndmask_b32 v35, v35, v52, s[44:45]
  s_waitcnt vmcnt(5)
  s_cmp_eq_u32 s58, 1
  s_cbranch_scc1 L_bo_36
  s_waitcnt vmcnt(4)
L_bo_36:
  s_add_u32 s41, s41, 0x4000
  buffer_load_dwordx4 v[160:163], v1, s[32:35], s41 offen offset:0 nt
  v_mfma_f32_16x16x32_bf16 v[24:27], v[136:139], v[16:19], v[24:27]
  s_waitcnt vmcnt(5)
  s_cmp_eq_u32 s58, 1
  s_nop 4
  s_cbranch_scc1 L_bo_37
  s_waitcnt vmcnt(4)
L_bo_37:
  buffer_load_dwordx4 v[164:167], v1, s[32:35], s41 offen offset:1024 nt
  v_mfma_f32_16x16x32_bf16 v[24:27], v[140:143], v[20:23], v[24:27]
  s_waitcnt vmcnt(5)
  s_cmp_eq_u32 s58, 1
  s_nop 4
  s_cbranch_scc1 L_bo_38
  s_waitcnt vmcnt(4)
L_bo_38:
  buffer_load_dwordx4 v[168:171], v1, s[32:35], s41 offen offset:2048 nt
  v_mfma_f32_16x16x32_bf16 v[28:31], v[144:147], v[8:11], 0
  s_waitcnt vmcnt(5)
  s_cmp_eq_u32 s58, 1
  s_nop 4
  s_cbranch_scc1 L_bo_39
  s_waitcnt vmcnt(4)
L_bo_39:
  buffer_load_dwordx4 v[172:175], v1, s[32:35], s41 offen offset:3072 nt
  v_mfma_f32_16x16x32_bf16 v[28:31], v[148:151], v[12:15], v[28:31]
  v_cndmask_b32 v52, v24, v25, s[44:45]
  v_cndmask_b32 v52, v52, v26, s[46:47]
  v_cndmask_b32 v52, v52, v27, s[48:49]
  s_nop 1
  v_add_f32_dpp v52, v52, v52 quad_perm:[1,0,3,2] row_mask:0xf bank_mask:0xf
  s_nop 1
  v_add_f32_dpp v52, v52, v52 quad_perm:[2,3,0,1] row_mask:0xf bank_mask:0xf
  v_cndmask_b32 v35, v35, v52, s[46:47]
  s_waitcnt vmcnt(5)
  s_cmp_eq_u32 s58, 1
  s_cbranch_scc1 L_bo_40
  s_waitcnt vmcnt(4)
L_bo_40:
  s_add_u32 s41, s41, 0x4000
  buffer_load_dwordx4 v[176:179], v1, s[32:35], s41 offen offset:0 nt
  v_mfma_f32_16x16x32_bf16 v[28:31], v[152:155], v[16:19], v[28:31]
  s_waitcnt vmcnt(5)
  s_cmp_eq_u32 s58, 1
  s_nop 4
  s_cbranch_scc1 L_bo_41
  s_waitcnt vmcnt(4)
L_bo_41:
  buffer_load_dwordx4 v[180:183], v1, s[32:35], s41 offen offset:1024 nt
  v_mfma_f32_16x16x32_bf16 v[28:31], v[156:159], v[20:23], v[28:31]
  s_waitcnt vmcnt(5)
  s_cmp_eq_u32 s58, 1
  s_nop 4
  s_cbranch_scc1 L_bo_42
  s_waitcnt vmcnt(4)
L_bo_42:
  buffer_load_dwordx4 v[184:187], v1, s[32:35], s41 offen offset:2048 nt
  v_mfma_f32_16x16x32_bf16 v[24:27], v[160:163], v[8:11], 0
  s_waitcnt vmcnt(5)
  s_cmp_eq_u32 s58, 1
  s_nop 4
  s_cbranch_scc1 L_bo_43
  s_waitcnt vmcnt(4)
L_bo_43:
  buffer_load_dwordx4 v[188:191], v1, s[32:35], s41 offen offset:3072 nt
  v_mfma_f32_16x16x32_bf16 v[24:27], v[164:167], v[12:15], v[24:27]
  v_cndmask_b32 v52, v28, v29, s[44:45]
  v_cndmask_b32 v52, v52, v30, s[46:47]
  v_cndmask_b32 v52, v52, v31, s[48:49]
  s_nop 1
  v_add_f32_dpp v52, v52, v52 quad_perm:[1,0,3,2] row_mask:0xf bank_mask:0xf
  s_nop 1
  v_add_f32_dpp v52, v52, v52 quad_perm:[2,3,0,1] row_mask:0xf bank_mask:0xf
  v_cndmask_b32 v35, v35, v52, s[48:49]
  s_waitcnt vmcnt(5)
  s_cmp_eq_u32 s58, 1
  s_cbranch_scc1 L_bo_44
  s_waitcnt vmcnt(4)
L_bo_44:
  s_add_u32 s41, s41, 0x4000
  buffer_load_dwordx4 v[192:195], v1, s[32:35], s41 offen offset:0 nt
  v_mfma_f32_16x16x32_bf16 v[24:27], v[168:171], v[16:19], v[24:27]
  s_waitcnt vmcnt(5)
  s_cmp_eq_u32 s58, 1
  s_nop 4
  s_cbranch_scc1 L_bo_45
  s_waitcnt vmcnt(4)
L_bo_45:
  buffer_load_dwordx4 v[196:199], v1, s[32:35], s41 offen offset:1024 nt
  v_mfma_f32_16x16x32_bf16 v[24:27], v[172:175], v[20:23], v[24:27]
  s_waitcnt vmcnt(5)
  s_cmp_eq_u32 s58, 1
  s_nop 4
  s_cbranch_scc1 L_bo_46
  s_waitcnt vmcnt(4)
L_bo_46:
  buffer_load_dwordx4 v[200:203], v1, s[32:35], s41 offen offset:2048 nt
  v_mfma_f32_16x16x32_bf16 v[28:31], v[176:179], v[8:11], 0
  s_waitcnt vmcnt(5)
  s_cmp_eq_u32 s58, 1
  s_nop 4
  s_cbranch_scc1 L_bo_47
  s_waitcnt vmcnt(4)
L_bo_47:
  buffer_load_dwordx4 v[204:207], v1, s[32:35], s41 offen offset:3072 nt
  v_mfma_f32_16x16x32_bf16 v[28:31], v[180:183], v[12:15], v[28:31]
  v_cndmask_b32 v52, v24, v25, s[44:45]
  v_cndmask_b32 v52, v52, v26, s[46:47]
  v_cndmask_b32 v52, v52, v27, s[48:49]
  s_nop 1
  v_add_f32_dpp v52, v52, v52 quad_perm:[1,0,3,2] row_mask:0xf bank_mask:0xf
  s_nop 1
  v_add_f32_dpp v36, v52, v52 quad_perm:[2,3,0,1] row_mask:0xf bank_mask:0xf
  s_waitcnt vmcnt(5)
  s_cmp_eq_u32 s58, 1
  s_cbranch_scc1 L_bo_48
  s_waitcnt vmcnt(4)
L_bo_48:
  s_add_u32 s41, s41, 0x4000
  buffer_load_dwordx4 v[208:211], v1, s[32:35], s41 offen offset:0 nt
  v_mfma_f32_16x16x32_bf16 v[28:31], v[184:187], v[16:19], v[28:31]
  s_waitcnt vmcnt(5)
  s_cmp_eq_u32 s58, 1
  s_nop 4
  s_cbranch_scc1 L_bo_49
  s_waitcnt vmcnt(4)
L_bo_49:
  buffer_load_dwordx4 v[212:215], v1, s[32:35], s41 offen offset:1024 nt
  v_mfma_f32_16x16x32_bf16 v[28:31], v[188:191], v[20:23], v[28:31]
  s_waitcnt vmcnt(5)
  s_cmp_eq_u32 s58, 1
  s_nop 4
  s_cbranch_scc1 L_bo_50
  s_waitcnt vmcnt(4)
L_bo_50:
  buffer_load_dwordx4 v[216:219], v1, s[32:35], s41 offen offset:2048 nt
  v_mfma_f32_16x16x32_bf16 v[24:27], v[192:195], v[8:11], 0
  s_waitcnt vmcnt(5)
  s_cmp_eq_u32 s58, 1
  s_nop 4
  s_cbranch_scc1 L_bo_51
  s_waitcnt vmcnt(4)
L_bo_51:
  buffer_load_dwordx4 v[220:223], v1, s[32:35], s41 offen offset:3072 nt
  v_mfma_f32_16x16x32_bf16 v[24:27], v[196:199], v[12:15], v[24:27]
  v_cndmask_b32 v52, v28, v29, s[44:45]
  v_cndmask_b32 v52, v52, v30, s[46:47]
  v_cndmask_b32 v52, v52, v31, s[48:49]
  s_nop 1
  v_add_f32_dpp v52, v52, v52 quad_perm:[1,0,3,2] row_mask:0xf bank_mask:0xf
  s_nop 1
  v_add_f32_dpp v52, v52, v52 quad_perm:[2,3,0,1] row_mask:0xf bank_mask:0xf
  v_cndmask_b32 v36, v36, v52, s[44:45]
  s_waitcnt vmcnt(5)
  s_cmp_eq_u32 s58, 1
  s_cbranch_scc1 L_bo_52
  s_waitcnt vmcnt(4)
L_bo_52:
  s_add_u32 s41, s41, 0x4000
  buffer_load_dwordx4 v[64:67], v1, s[32:35], s41 offen offset:0 nt
  v_mfma_f32_16x16x32_bf16 v[24:27], v[200:203], v[16:19], v[24:27]
  s_waitcnt vmcnt(5)
  s_cmp_eq_u32 s58, 1
  s_nop 4
  s_cbranch_scc1 L_bo_53
  s_waitcnt vmcnt(4)
L_bo_53:
  buffer_load_dwordx4 v[68:71], v1, s[32:35], s41 offen offset:1024 nt
  v_mfma_f32_16x16x32_bf16 v[24:27], v[204:207], v[20:23], v[24:27]
  s_waitcnt vmcnt(5)
  s_cmp_eq_u32 s58, 1
  s_nop 4
  s_cbranch_scc1 L_bo_54
  s_waitcnt vmcnt(4)
L_bo_54:
  buffer_load_dwordx4 v[72:75], v1, s[32:35], s41 offen offset:2048 nt
  v_mfma_f32_16x16x32_bf16 v[28:31], v[208:211], v[8:11], 0
  s_waitcnt vmcnt(5)
  s_cmp_eq_u32 s58, 1
  s_nop 4
  s_cbranch_scc1 L_bo_55
  s_waitcnt vmcnt(4)
L_bo_55:
  buffer_load_dwordx4 v[76:79], v1, s[32:35], s41 offen offset:3072 nt
  v_mfma_f32_16x16x32_bf16 v[28:31], v[212:215], v[12:15], v[28:31]
  v_cndmask_b32 v52, v24, v25, s[44:45]
  v_cndmask_b32 v52, v52, v26, s[46:47]
  v_cndmask_b32 v52, v52, v27, s[48:49]
  s_nop 1
  v_add_f32_dpp v52, v52, v52 quad_perm:[1,0,3,2] row_mask:0xf bank_mask:0xf
  s_nop 1
  v_add_f32_dpp v52, v52, v52 quad_perm:[2,3,0,1] row_mask:0xf bank_mask:0xf
  v_cndmask_b32 v36, v36, v52, s[46:47]
  s_waitcnt vmcnt(5)
  s_cmp_eq_u32 s58, 1
  s_cbranch_scc1 L_bo_56
  s_waitcnt vmcnt(4)
L_bo_56:
  s_add_u32 s41, s41, 0x4000
  buffer_load_dwordx4 v[80:83], v1, s[32:35], s41 offen offset:0 nt
  v_mfma_f32_16x16x32_bf16 v[28:31], v[216:219], v[16:19], v[28:31]
  s_waitcnt vmcnt(5)
  s_cmp_eq_u32 s58, 1
  s_nop 4
  s_cbranch_scc1 L_bo_57
  s_waitcnt vmcnt(4)
L_bo_57:
  buffer_load_dwordx4 v[84:87], v1, s[32:35], s41 offen offset:1024 nt
  v_mfma_f32_16x16x32_bf16 v[28:31], v[220:223], v[20:23], v[28:31]
  s_cmp_lg_u32 s3, 0
  s_nop 5
  s_cbranch_scc1 L_pf_58
  v_mov_b32 v62, 0
  v_mov_b32 v63, 1
  ds_write_b32 v62, v63 offset:13492
L_pf_58:
  s_waitcnt vmcnt(5)
  s_cmp_eq_u32 s58, 1
  s_cbranch_scc1 L_bo_59
  s_waitcnt vmcnt(4)
L_bo_59:
  buffer_load_dwordx4 v[88:91], v1, s[32:35], s41 offen offset:2048 nt
  v_mfma_f32_16x16x32_bf16 v[24:27], v[64:67], v[8:11], 0
  s_waitcnt vmcnt(5)
  s_cmp_eq_u32 s58, 1
  s_nop 4
  s_cbranch_scc1 L_bo_60
  s_waitcnt vmcnt(4)
L_bo_60:
  buffer_load_dwordx4 v[92:95], v1, s[32:35], s41 offen offset:3072 nt
  v_mfma_f32_16x16x32_bf16 v[24:27], v[68:71], v[12:15], v[24:27]
  v_cndmask_b32 v52, v28, v29, s[44:45]
  v_cndmask_b32 v52, v52, v30, s[46:47]
  v_cndmask_b32 v52, v52, v31, s[48:49]
  s_nop 1
  v_add_f32_dpp v52, v52, v52 quad_perm:[1,0,3,2] row_mask:0xf bank_mask:0xf
  s_nop 1
  v_add_f32_dpp v52, v52, v52 quad_perm:[2,3,0,1] row_mask:0xf bank_mask:0xf
  v_cndmask_b32 v36, v36, v52, s[48:49]
  s_waitcnt vmcnt(5)
  s_cmp_eq_u32 s58, 1
  s_cbranch_scc1 L_bo_61
  s_waitcnt vmcnt(4)
L_bo_61:
  s_add_u32 s41, s41, 0x4000
  buffer_load_dwordx4 v[96:99], v1, s[32:35], s41 offen offset:0 nt
  v_mfma_f32_16x16x32_bf16 v[24:27], v[72:75], v[16:19], v[24:27]
  s_waitcnt vmcnt(5)
  s_cmp_eq_u32 s58, 1
  s_nop 4
  s_cbranch_scc1 L_bo_62
  s_waitcnt vmcnt(4)
L_bo_62:
  buffer_load_dwordx4 v[100:103], v1, s[32:35], s41 offen offset:1024 nt
  v_mfma_f32_16x16x32_bf16 v[24:27], v[76:79], v[20:23], v[24:27]
  s_waitcnt vmcnt(5)
  s_cmp_eq_u32 s58, 1
  s_nop 4
  s_cbranch_scc1 L_bo_63
  s_waitcnt vmcnt(4)
L_bo_63:
  buffer_load_dwordx4 v[104:107], v1, s[32:35], s41 offen offset:2048 nt
  v_mfma_f32_16x16x32_bf16 v[28:31], v[80:83], v[8:11], 0
  s_waitcnt vmcnt(5)
  s_cmp_eq_u32 s58, 1
  s_nop 4
  s_cbranch_scc1 L_bo_64
  s_waitcnt vmcnt(4)
L_bo_64:
  buffer_load_dwordx4 v[108:111], v1, s[32:35], s41 offen offset:3072 nt
  v_mfma_f32_16x16x32_bf16 v[28:31], v[84:87], v[12:15], v[28:31]
  v_cndmask_b32 v52, v24, v25, s[44:45]
  v_cndmask_b32 v52, v52, v26, s[46:47]
  v_cndmask_b32 v52, v52, v27, s[48:49]
  s_nop 1
  v_add_f32_dpp v52, v52, v52 quad_perm:[1,0,3,2] row_mask:0xf bank_mask:0xf
  s_nop 1
  v_add_f32_dpp v37, v52, v52 quad_perm:[2,3,0,1] row_mask:0xf bank_mask:0xf
  s_waitcnt vmcnt(5)
  s_cmp_eq_u32 s58, 1
  s_cbranch_scc1 L_bo_65
  s_waitcnt vmcnt(4)
L_bo_65:
  s_add_u32 s41, s41, 0x4000
  buffer_load_dwordx4 v[112:115], v1, s[32:35], s41 offen offset:0 nt
  v_mfma_f32_16x16x32_bf16 v[28:31], v[88:91], v[16:19], v[28:31]
  s_waitcnt vmcnt(5)
  s_cmp_eq_u32 s58, 1
  s_nop 4
  s_cbranch_scc1 L_bo_66
  s_waitcnt vmcnt(4)
L_bo_66:
  buffer_load_dwordx4 v[116:119], v1, s[32:35], s41 offen offset:1024 nt
  v_mfma_f32_16x16x32_bf16 v[28:31], v[92:95], v[20:23], v[28:31]
  s_waitcnt vmcnt(5)
  s_cmp_eq_u32 s58, 1
  s_nop 4
  s_cbranch_scc1 L_bo_67
  s_waitcnt vmcnt(4)
L_bo_67:
  buffer_load_dwordx4 v[120:123], v1, s[32:35], s41 offen offset:2048 nt
  v_mfma_f32_16x16x32_bf16 v[24:27], v[96:99], v[8:11], 0
  s_waitcnt vmcnt(5)
  s_cmp_eq_u32 s58, 1
  s_nop 4
  s_cbranch_scc1 L_bo_68
  s_waitcnt vmcnt(4)
L_bo_68:
  buffer_load_dwordx4 v[124:127], v1, s[32:35], s41 offen offset:3072 nt
  v_mfma_f32_16x16x32_bf16 v[24:27], v[100:103], v[12:15], v[24:27]
  v_cndmask_b32 v52, v28, v29, s[44:45]
  v_cndmask_b32 v52, v52, v30, s[46:47]
  v_cndmask_b32 v52, v52, v31, s[48:49]
  s_nop 1
  v_add_f32_dpp v52, v52, v52 quad_perm:[1,0,3,2] row_mask:0xf bank_mask:0xf
  s_nop 1
  v_add_f32_dpp v52, v52, v52 quad_perm:[2,3,0,1] row_mask:0xf bank_mask:0xf
  v_cndmask_b32 v37, v37, v52, s[44:45]
  s_waitcnt vmcnt(5)
  s_cmp_eq_u32 s58, 1
  s_cbranch_scc1 L_bo_69
  s_waitcnt vmcnt(4)
L_bo_69:
  s_add_u32 s41, s41, 0x4000
  buffer_load_dwordx4 v[128:131], v1, s[32:35], s41 offen offset:0 nt
  v_mfma_f32_16x16x32_bf16 v[24:27], v[104:107], v[16:19], v[24:27]
  s_waitcnt vmcnt(5)
  s_cmp_eq_u32 s58, 1
  s_nop 4
  s_cbranch_scc1 L_bo_70
  s_waitcnt vmcnt(4)
L_bo_70:
  buffer_load_dwordx4 v[132:135], v1, s[32:35], s41 offen offset:1024 nt
  v_mfma_f32_16x16x32_bf16 v[24:27], v[108:111], v[20:23], v[24:27]
  s_waitcnt vmcnt(5)
  s_cmp_eq_u32 s58, 1
  s_nop 4
  s_cbranch_scc1 L_bo_71
  s_waitcnt vmcnt(4)
L_bo_71:
  buffer_load_dwordx4 v[136:139], v1, s[32:35], s41 offen offset:2048 nt
  v_mfma_f32_16x16x32_bf16 v[28:31], v[112:115], v[8:11], 0
  s_waitcnt vmcnt(5)
  s_cmp_eq_u32 s58, 1
  s_nop 4
  s_cbranch_scc1 L_bo_72
  s_waitcnt vmcnt(4)
L_bo_72:
  buffer_load_dwordx4 v[140:143], v1, s[32:35], s41 offen offset:3072 nt
  v_mfma_f32_16x16x32_bf16 v[28:31], v[116:119], v[12:15], v[28:31]
  v_cndmask_b32 v52, v24, v25, s[44:45]
  v_cndmask_b32 v52, v52, v26, s[46:47]
  v_cndmask_b32 v52, v52, v27, s[48:49]
  s_nop 1
  v_add_f32_dpp v52, v52, v52 quad_perm:[1,0,3,2] row_mask:0xf bank_mask:0xf
  s_nop 1
  v_add_f32_dpp v52, v52, v52 quad_perm:[2,3,0,1] row_mask:0xf bank_mask:0xf
  v_cndmask_b32 v37, v37, v52, s[46:47]
  s_waitcnt vmcnt(5)
  s_cmp_eq_u32 s58, 1
  s_cbranch_scc1 L_bo_73
  s_waitcnt vmcnt(4)
L_bo_73:
  s_add_u32 s41, s41, 0x4000
  buffer_load_dwordx4 v[144:147], v1, s[32:35], s41 offen offset:0 nt
  v_mfma_f32_16x16x32_bf16 v[28:31], v[120:123], v[16:19], v[28:31]
  s_waitcnt vmcnt(5)
  s_cmp_eq_u32 s58, 1
  s_nop 4
  s_cbranch_scc1 L_bo_74
  s_waitcnt vmcnt(4)
L_bo_74:
  buffer_load_dwordx4 v[148:151], v1, s[32:35], s41 offen offset:1024 nt
  v_mfma_f32_16x16x32_bf16 v[28:31], v[124:127], v[20:23], v[28:31]
  s_waitcnt vmcnt(5)
  v_mfma_f32_16x16x32_bf16 v[24:27], v[128:131], v[8:11], 0
  s_waitcnt vmcnt(4)
  buffer_load_dwordx4 v[152:155], v1, s[32:35], s41 offen offset:2048 nt
  v_mfma_f32_16x16x32_bf16 v[24:27], v[132:135], v[12:15], v[24:27]
  s_nop 2
  v_cndmask_b32 v52, v28, v29, s[44:45]
  v_cndmask_b32 v52, v52, v30, s[46:47]
  v_cndmask_b32 v52, v52, v31, s[48:49]
  s_nop 1
  v_add_f32_dpp v52, v52, v52 quad_perm:[1,0,3,2] row_mask:0xf bank_mask:0xf
  s_nop 1
  v_add_f32_dpp v52, v52, v52 quad_perm:[2,3,0,1] row_mask:0xf bank_mask:0xf
  v_cndmask_b32 v37, v37, v52, s[48:49]
  s_waitcnt vmcnt(4)
  buffer_load_dwordx4 v[156:159], v1, s[32:35], s41 offen offset:3072 nt
  v_mfma_f32_16x16x32_bf16 v[24:27], v[136:139], v[16:19], v[24:27]
  s_waitcnt vmcnt(4)
  s_add_u32 s41, s41, 0x4000
  buffer_load_dwordx4 v[160:163], v1, s[32:35], s41 offen offset:0 nt
  v_mfma_f32_16x16x32_bf16 v[24:27], v[140:143], v[20:23], v[24:27]
  s_waitcnt vmcnt(4)
  buffer_load_dwordx4 v[164:167], v1, s[32:35], s41 offen offset:1024 nt
  v_mfma_f32_16x16x32_bf16 v[28:31], v[144:147], v[8:11], 0
  s_waitcnt vmcnt(4)
  buffer_load_dwordx4 v[168:171], v1, s[32:35], s41 offen offset:2048 nt
  v_mfma_f32_16x16x32_bf16 v[28:31], v[148:151], v[12:15], v[28:31]
  s_nop 1
  v_cndmask_b32 v52, v24, v25, s[44:45]
  v_cndmask_b32 v52, v52, v26, s[46:47]
  v_cndmask_b32 v52, v52, v27, s[48:49]
  s_nop 1
  v_add_f32_dpp v52, v52, v52 quad_perm:[1,0,3,2] row_mask:0xf bank_mask:0xf
  s_nop 1
  v_add_f32_dpp v38, v52, v52 quad_perm:[2,3,0,1] row_mask:0xf bank_mask:0xf
  s_waitcnt vmcnt(4)
  buffer_load_dwordx4 v[172:175], v1, s[32:35], s41 offen offset:3072 nt
  v_mfma_f32_16x16x32_bf16 v[28:31], v[152:155], v[16:19], v[28:31]
  s_waitcnt vmcnt(4)
  s_add_u32 s41, s41, 0x4000
  buffer_load_dwordx4 v[176:179], v1, s[32:35], s41 offen offset:0 nt
  v_mfma_f32_16x16x32_bf16 v[28:31], v[156:159], v[20:23], v[28:31]
  s_waitcnt vmcnt(4)
  buffer_load_dwordx4 v[180:183], v1, s[32:35], s41 offen offset:1024 nt
  v_mfma_f32_16x16x32_bf16 v[24:27], v[160:163], v[8:11], 0
  s_waitcnt vmcnt(4)
  buffer_load_dwordx4 v[184:187], v1, s[32:35], s41 offen offset:2048 nt
  v_mfma_f32_16x16x32_bf16 v[24:27], v[164:167], v[12:15], v[24:27]
  s_nop 1
  v_cndmask_b32 v52, v28, v29, s[44:45]
  v_cndmask_b32 v52, v52, v30, s[46:47]
  v_cndmask_b32 v52, v52, v31, s[48:49]
  s_nop 1
  v_add_f32_dpp v52, v52, v52 quad_perm:[1,0,3,2] row_mask:0xf bank_mask:0xf
  s_nop 1
  v_add_f32_dpp v52, v52, v52 quad_perm:[2,3,0,1] row_mask:0xf bank_mask:0xf
  v_cndmask_b32 v38, v38, v52, s[44:45]
  s_waitcnt vmcnt(4)
  buffer_load_dwordx4 v[188:191], v1, s[32:35], s41 offen offset:3072 nt
  v_mfma_f32_16x16x32_bf16 v[24:27], v[168:171], v[16:19], v[24:27]
  s_waitcnt vmcnt(4)
  s_add_u32 s41, s41, 0x4000
  buffer_load_dwordx4 v[192:195], v1, s[32:35], s41 offen offset:0 nt
  v_mfma_f32_16x16x32_bf16 v[24:27], v[172:175], v[20:23], v[24:27]
  s_waitcnt vmcnt(4)
  buffer_load_dwordx4 v[196:199], v1, s[32:35], s41 offen offset:1024 nt
  v_mfma_f32_16x16x32_bf16 v[28:31], v[176:179], v[8:11], 0
  s_waitcnt vmcnt(4)
  buffer_load_dwordx4 v[200:203], v1, s[32:35], s41 offen offset:2048 nt
  v_mfma_f32_16x16x32_bf16 v[28:31], v[180:183], v[12:15], v[28:31]
  s_nop 1
  v_cndmask_b32 v52, v24, v25, s[44:45]
  v_cndmask_b32 v52, v52, v26, s[46:47]
  v_cndmask_b32 v52, v52, v27, s[48:49]
  s_nop 1
  v_add_f32_dpp v52, v52, v52 quad_perm:[1,0,3,2] row_mask:0xf bank_mask:0xf
  s_nop 1
  v_add_f32_dpp v52, v52, v52 quad_perm:[2,3,0,1] row_mask:0xf bank_mask:0xf
  v_cndmask_b32 v38, v38, v52, s[46:47]
  s_waitcnt vmcnt(4)
  buffer_load_dwordx4 v[204:207], v1, s[32:35], s41 offen offset:3072 nt
  v_mfma_f32_16x16x32_bf16 v[28:31], v[184:187], v[16:19], v[28:31]
  s_waitcnt vmcnt(4)
  s_add_u32 s41, s41, 0x4000
  buffer_load_dwordx4 v[208:211], v1, s[32:35], s41 offen offset:0 nt
  v_mfma_f32_16x16x32_bf16 v[28:31], v[188:191], v[20:23], v[28:31]
  s_waitcnt vmcnt(4)
  buffer_load_dwordx4 v[212:215], v1, s[32:35], s41 offen offset:1024 nt
  v_mfma_f32_16x16x32_bf16 v[24:27], v[192:195], v[8:11], 0
  s_waitcnt vmcnt(4)
  buffer_load_dwordx4 v[216:219], v1, s[32:35], s41 offen offset:2048 nt
  v_mfma_f32_16x16x32_bf16 v[24:27], v[196:199], v[12:15], v[24:27]
  s_nop 1
  v_cndmask_b32 v52, v28, v29, s[44:45]
  v_cndmask_b32 v52, v52, v30, s[46:47]
  v_cndmask_b32 v52, v52, v31, s[48:49]
  s_nop 1
  v_add_f32_dpp v52, v52, v52 quad_perm:[1,0,3,2] row_mask:0xf bank_mask:0xf
  s_nop 1
  v_add_f32_dpp v52, v52, v52 quad_perm:[2,3,0,1] row_mask:0xf bank_mask:0xf
  v_cndmask_b32 v38, v38, v52, s[48:49]
  s_waitcnt vmcnt(4)
  buffer_load_dwordx4 v[220:223], v1, s[32:35], s41 offen offset:3072 nt
  v_mfma_f32_16x16x32_bf16 v[24:27], v[200:203], v[16:19], v[24:27]
  s_waitcnt vmcnt(4)
  s_add_u32 s41, s41, 0x4000
  buffer_load_dwordx4 v[64:67], v1, s[32:35], s41 offen offset:0 nt
  v_mfma_f32_16x16x32_bf16 v[24:27], v[204:207], v[20:23], v[24:27]
  s_waitcnt vmcnt(4)
  buffer_load_dwordx4 v[68:71], v1, s[32:35], s41 offen offset:1024 nt
  v_mfma_f32_16x16x32_bf16 v[28:31], v[208:211], v[8:11], 0
  s_waitcnt vmcnt(4)
  buffer_load_dwordx4 v[72:75], v1, s[32:35], s41 offen offset:2048 nt
  v_mfma_f32_16x16x32_bf16 v[28:31], v[212:215], v[12:15], v[28:31]
  s_nop 1
  v_cndmask_b32 v52, v24, v25, s[44:45]
  v_cndmask_b32 v52, v52, v26, s[46:47]
  v_cndmask_b32 v52, v52, v27, s[48:49]
  s_nop 1
  v_add_f32_dpp v52, v52, v52 quad_perm:[1,0,3,2] row_mask:0xf bank_mask:0xf
  s_nop 1
  v_add_f32_dpp v39, v52, v52 quad_perm:[2,3,0,1] row_mask:0xf bank_mask:0xf
  s_waitcnt vmcnt(4)
  buffer_load_dwordx4 v[76:79], v1, s[32:35], s41 offen offset:3072 nt
  v_mfma_f32_16x16x32_bf16 v[28:31], v[216:219], v[16:19], v[28:31]
  s_waitcnt vmcnt(4)
  s_add_u32 s41, s41, 0x4000
  buffer_load_dwordx4 v[80:83], v1, s[32:35], s41 offen offset:0 nt
  v_mfma_f32_16x16x32_bf16 v[28:31], v[220:223], v[20:23], v[28:31]
  s_waitcnt vmcnt(4)
  buffer_load_dwordx4 v[84:87], v1, s[32:35], s41 offen offset:1024 nt
  v_mfma_f32_16x16x32_bf16 v[24:27], v[64:67], v[8:11], 0
  s_waitcnt vmcnt(4)
  buffer_load_dwordx4 v[88:91], v1, s[32:35], s41 offen offset:2048 nt
  v_mfma_f32_16x16x32_bf16 v[24:27], v[68:71], v[12:15], v[24:27]
  s_nop 1
  v_cndmask_b32 v52, v28, v29, s[44:45]
  v_cndmask_b32 v52, v52, v30, s[46:47]
  v_cndmask_b32 v52, v52, v31, s[48:49]
  s_nop 1
  v_add_f32_dpp v52, v52, v52 quad_perm:[1,0,3,2] row_mask:0xf bank_mask:0xf
  s_nop 1
  v_add_f32_dpp v52, v52, v52 quad_perm:[2,3,0,1] row_mask:0xf bank_mask:0xf
  v_cndmask_b32 v39, v39, v52, s[44:45]
  s_waitcnt vmcnt(4)
  buffer_load_dwordx4 v[92:95], v1, s[32:35], s41 offen offset:3072 nt
  v_mfma_f32_16x16x32_bf16 v[24:27], v[72:75], v[16:19], v[24:27]
  s_waitcnt vmcnt(4)
  s_mov_b32 s41, s40
  buffer_load_dwordx4 v[96:99], v2, s[36:39], s41 offen offset:0 nt
  v_mfma_f32_16x16x32_bf16 v[24:27], v[76:79], v[20:23], v[24:27]
  s_waitcnt vmcnt(4)
  buffer_load_dwordx4 v[100:103], v2, s[36:39], s41 offen offset:1024 nt
  v_mfma_f32_16x16x32_bf16 v[28:31], v[80:83], v[8:11], 0
  s_waitcnt vmcnt(4)
  buffer_load_dwordx4 v[104:107], v2, s[36:39], s41 offen offset:2048 nt
  v_mfma_f32_16x16x32_bf16 v[28:31], v[84:87], v[12:15], v[28:31]
  s_nop 1
  v_cndmask_b32 v52, v24, v25, s[44:45]
  v_cndmask_b32 v52, v52, v26, s[46:47]
  v_cndmask_b32 v52, v52, v27, s[48:49]
  s_nop 1
  v_add_f32_dpp v52, v52, v52 quad_perm:[1,0,3,2] row_mask:0xf bank_mask:0xf
  s_nop 1
  v_add_f32_dpp v52, v52, v52 quad_perm:[2,3,0,1] row_mask:0xf bank_mask:0xf
  v_cndmask_b32 v39, v39, v52, s[46:47]
  s_waitcnt vmcnt(4)
  buffer_load_dwordx4 v[108:111], v2, s[36:39], s41 offen offset:3072 nt
  v_mfma_f32_16x16x32_bf16 v[28:31], v[88:91], v[16:19], v[28:31]
  s_waitcnt vmcnt(4)
  s_add_u32 s41, s41, 0x4000
  buffer_load_dwordx4 v[112:115], v2, s[36:39], s41 offen offset:0 nt
  v_mfma_f32_16x16x32_bf16 v[28:31], v[92:95], v[20:23], v[28:31]
  s_waitcnt vmcnt(4)
  buffer_load_dwordx4 v[116:119], v2, s[36:39], s41 offen offset:1024 nt
  s_nop 5
  v_cndmask_b32 v52, v28, v29, s[44:45]
  v_cndmask_b32 v52, v52, v30, s[46:47]
  v_cndmask_b32 v52, v52, v31, s[48:49]
  s_nop 1
  v_add_f32_dpp v52, v52, v52 quad_perm:[1,0,3,2] row_mask:0xf bank_mask:0xf
  s_nop 1
  v_add_f32_dpp v52, v52, v52 quad_perm:[2,3,0,1] row_mask:0xf bank_mask:0xf
  v_cndmask_b32 v39, v39, v52, s[48:49]
  v_cvt_pk_bf16_f32 v52, v32, v33
  v_cvt_pk_bf16_f32 v53, v34, v35
  v_cvt_pk_bf16_f32 v54, v36, v37
  v_cvt_pk_bf16_f32 v55, v38, v39
  v_lshlrev_b32 v32, 16, v52
  v_and_b32 v33, 0xffff0000, v52
  v_lshlrev_b32 v34, 16, v53
  v_and_b32 v35, 0xffff0000, v53
  v_lshlrev_b32 v36, 16, v54
  v_and_b32 v37, 0xffff0000, v54
  v_lshlrev_b32 v38, 16, v55
  v_and_b32 v39, 0xffff0000, v55
  v_mul_f32 v32, 0x3db504f3, v32
  v_mul_f32 v33, 0x3db504f3, v33
  v_mul_f32 v34, 0x3db504f3, v34
  v_mul_f32 v35, 0x3db504f3, v35
  v_mul_f32 v36, 0x3db504f3, v36
  v_mul_f32 v37, 0x3db504f3, v37
  v_mul_f32 v38, 0x3db504f3, v38
  v_mul_f32 v39, 0x3db504f3, v39
  v_cvt_pk_bf16_f32 v52, v32, v33
  v_cvt_pk_bf16_f32 v53, v34, v35
  v_cvt_pk_bf16_f32 v54, v36, v37
  v_cvt_pk_bf16_f32 v55, v38, v39
  v_lshlrev_b32 v32, 16, v52
  v_and_b32 v33, 0xffff0000, v52
  v_lshlrev_b32 v34, 16, v53
  v_and_b32 v35, 0xffff0000, v53
  v_lshlrev_b32 v36, 16, v54
  v_and_b32 v37, 0xffff0000, v54
  v_lshlrev_b32 v38, 16, v55
  v_and_b32 v39, 0xffff0000, v55
  v_max3_f32 v56, v32, v33, v34
  v_max3_f32 v56, v56, v35, v36
  v_max3_f32 v56, v56, v37, v38
  v_max_f32 v56, v56, v39
  s_nop 1
  v_max_f32_dpp v56, v56, v56 quad_perm:[1,0,3,2] row_mask:0xf bank_mask:0xf
  s_nop 1
  v_max_f32_dpp v56, v56, v56 quad_perm:[2,3,0,1] row_mask:0xf bank_mask:0xf
  s_nop 1
  v_max_f32_dpp v56, v56, v56 row_half_mirror row_mask:0xf bank_mask:0xf
  s_nop 1
  v_max_f32_dpp v56, v56, v56 row_mirror row_mask:0xf bank_mask:0xf
  v_mov_b32 v57, v56
  s_nop 1
  v_permlane16_swap_b32 v56, v57
  v_max_f32 v56, v56, v57
  v_mov_b32 v57, v56
  s_nop 1
  v_permlane32_swap_b32 v56, v57
  v_max_f32 v56, v56, v57
  s_waitcnt vmcnt(4)
  buffer_load_dwordx4 v[120:123], v2, s[36:39], s41 offen offset:2048 nt
  v_sub_f32 v32, v32, v56
  v_sub_f32 v33, v33, v56
  v_sub_f32 v34, v34, v56
  v_sub_f32 v35, v35, v56
  v_sub_f32 v36, v36, v56
  v_sub_f32 v37, v37, v56
  v_sub_f32 v38, v38, v56
  v_sub_f32 v39, v39, v56
  v_mul_f32 v32, 0x3fb8aa3b, v32
  v_mul_f32 v33, 0x3fb8aa3b, v33
  v_mul_f32 v34, 0x3fb8aa3b, v34
  v_mul_f32 v35, 0x3fb8aa3b, v35
  v_mul_f32 v36, 0x3fb8aa3b, v36
  v_mul_f32 v37, 0x3fb8aa3b, v37
  v_mul_f32 v38, 0x3fb8aa3b, v38
  v_mul_f32 v39, 0x3fb8aa3b, v39
  v_exp_f32 v32, v32
  v_exp_f32 v33, v33
  v_exp_f32 v34, v34
  v_exp_f32 v35, v35
  v_exp_f32 v36, v36
  v_exp_f32 v37, v37
  v_exp_f32 v38, v38
  v_exp_f32 v39, v39
  v_add_f32 v57, v32, v33
  v_add_f32 v58, v34, v35
  v_add_f32 v57, v57, v36
  v_add_f32 v58, v58, v37
  v_add_f32 v57, v57, v38
  v_add_f32 v58, v58, v39
  v_add_f32 v57, v57, v58
  v_cvt_pk_bf16_f32 v32, v32, v32
  v_cvt_pk_bf16_f32 v33, v33, v33
  v_cvt_pk_bf16_f32 v34, v34, v34
  v_cvt_pk_bf16_f32 v35, v35, v35
  v_cvt_pk_bf16_f32 v36, v36, v36
  v_cvt_pk_bf16_f32 v37, v37, v37
  v_cvt_pk_bf16_f32 v38, v38, v38
  v_cvt_pk_bf16_f32 v39, v39, v39
  v_add_f32_dpp v57, v57, v57 quad_perm:[1,0,3,2] row_mask:0xf bank_mask:0xf
  s_nop 1
  v_add_f32_dpp v57, v57, v57 quad_perm:[2,3,0,1] row_mask:0xf bank_mask:0xf
  s_nop 1
  v_add_f32_dpp v57, v57, v57 row_half_mirror row_mask:0xf bank_mask:0xf
  s_nop 1
  v_add_f32_dpp v57, v57, v57 row_mirror row_mask:0xf bank_mask:0xf
  v_mov_b32 v58, v57
  s_nop 1
  v_permlane16_swap_b32 v57, v58
  v_add_f32 v57, v57, v58
  v_mov_b32 v58, v57
  s_nop 1
  v_permlane32_swap_b32 v57, v58
  v_add_f32 v57, v57, v58
  s_waitcnt vmcnt(4)
  buffer_load_dwordx4 v[124:127], v2, s[36:39], s41 offen offset:3072 nt
  v_cmp_eq_u32 vcc, -1, v56
  v_mov_b32 v58, 0x7fc00000
  s_nop 0
  v_cndmask_b32 v56, v56, v58, vcc
  s_lshl_b32 s60, s3, 3
  v_mov_b32 v58, s60
  ds_write_b64 v58, v[56:57] offset:13312
  v_and_b32_dpp v44, v32, v4 row_newbcast:0 row_mask:0xf bank_mask:0xf
  v_and_b32_dpp v45, v32, v5 row_newbcast:0 row_mask:0xf bank_mask:0xf
  v_and_b32_dpp v46, v32, v6 row_newbcast:0 row_mask:0xf bank_mask:0xf
  v_and_b32_dpp v47, v32, v7 row_newbcast:0 row_mask:0xf bank_mask:0xf
  v_and_b32_dpp v48, v32, v4 row_newbcast:4 row_mask:0xf bank_mask:0xf
  v_and_b32_dpp v49, v32, v5 row_newbcast:4 row_mask:0xf bank_mask:0xf
  v_and_b32_dpp v50, v32, v6 row_newbcast:4 row_mask:0xf bank_mask:0xf
  v_and_b32_dpp v51, v32, v7 row_newbcast:4 row_mask:0xf bank_mask:0xf
  v_mfma_f32_16x16x32_bf16 v[40:43], v[96:99], v[44:47], 0
  v_and_b32_dpp v44, v32, v4 row_newbcast:8 row_mask:0xf bank_mask:0xf
  v_and_b32_dpp v45, v32, v5 row_newbcast:8 row_mask:0xf bank_mask:0xf
  v_and_b32_dpp v46, v32, v6 row_newbcast:8 row_mask:0xf bank_mask:0xf
  v_and_b32_dpp v47, v32, v7 row_newbcast:8 row_mask:0xf bank_mask:0xf
  v_mfma_f32_16x16x32_bf16 v[40:43], v[100:103], v[48:51], v[40:43]
  v_and_b32_dpp v48, v32, v4 row_newbcast:12 row_mask:0xf bank_mask:0xf
  v_and_b32_dpp v49, v32, v5 row_newbcast:12 row_mask:0xf bank_mask:0xf
  v_and_b32_dpp v50, v32, v6 row_newbcast:12 row_mask:0xf bank_mask:0xf
  v_and_b32_dpp v51, v32, v7 row_newbcast:12 row_mask:0xf bank_mask:0xf
  v_mfma_f32_16x16x32_bf16 v[40:43], v[104:107], v[44:47], v[40:43]
  s_waitcnt vmcnt(4)
  s_add_u32 s41, s41, 0x4000
  buffer_load_dwordx4 v[128:131], v2, s[36:39], s41 offen offset:0 nt
  v_and_b32_dpp v44, v32, v4 row_newbcast:1 row_mask:0xf bank_mask:0xf
  v_and_b32_dpp v45, v32, v5 row_newbcast:1 row_mask:0xf bank_mask:0xf
  v_and_b32_dpp v46, v32, v6 row_newbcast:1 row_mask:0xf bank_mask:0xf
  v_and_b32_dpp v47, v32, v7 row_newbcast:1 row_mask:0xf bank_mask:0xf
  v_mfma_f32_16x16x32_bf16 v[40:43], v[108:111], v[48:51], v[40:43]
  s_waitcnt vmcnt(4)
  buffer_load_dwordx4 v[132:135], v2, s[36:39], s41 offen offset:1024 nt
  v_and_b32_dpp v48, v32, v4 row_newbcast:5 row_mask:0xf bank_mask:0xf
  v_and_b32_dpp v49, v32, v5 row_newbcast:5 row_mask:0xf bank_mask:0xf
  v_and_b32_dpp v50, v32, v6 row_newbcast:5 row_mask:0xf bank_mask:0xf
  v_and_b32_dpp v51, v32, v7 row_newbcast:5 row_mask:0xf bank_mask:0xf
  v_mfma_f32_16x16x32_bf16 v[40:43], v[112:115], v[44:47], v[40:43]
  s_waitcnt vmcnt(4)
  buffer_load_dwordx4 v[136:139], v2, s[36:39], s41 offen offset:2048 nt
  v_and_b32_dpp v44, v32, v4 row_newbcast:9 row_mask:0xf bank_mask:0xf
  v_and_b32_dpp v45, v32, v5 row_newbcast:9 row_mask:0xf bank_mask:0xf
  v_and_b32_dpp v46, v32, v6 row_newbcast:9 row_mask:0xf bank_mask:0xf
  v_and_b32_dpp v47, v32, v7 row_newbcast:9 row_mask:0xf bank_mask:0xf
  v_mfma_f32_16x16x32_bf16 v[40:43], v[116:119], v[48:51], v[40:43]
  s_waitcnt vmcnt(4)
  buffer_load_dwordx4 v[140:143], v2, s[36:39], s41 offen offset:3072 nt
  v_and_b32_dpp v48, v32, v4 row_newbcast:13 row_mask:0xf bank_mask:0xf
  v_and_b32_dpp v49, v32, v5 row_newbcast:13 row_mask:0xf bank_mask:0xf
  v_and_b32_dpp v50, v32, v6 row_newbcast:13 row_mask:0xf bank_mask:0xf
  v_and_b32_dpp v51, v32, v7 row_newbcast:13 row_mask:0xf bank_mask:0xf
  v_mfma_f32_16x16x32_bf16 v[40:43], v[120:123], v[44:47], v[40:43]
  s_waitcnt vmcnt(4)
  s_add_u32 s41, s41, 0x4000
  buffer_load_dwordx4 v[144:147], v2, s[36:39], s41 offen offset:0 nt
  v_and_b32_dpp v44, v32, v4 row_newbcast:2 row_mask:0xf bank_mask:0xf
  v_and_b32_dpp v45, v32, v5 row_newbcast:2 row_mask:0xf bank_mask:0xf
  v_and_b32_dpp v46, v32, v6 row_newbcast:2 row_mask:0xf bank_mask:0xf
  v_and_b32_dpp v47, v32, v7 row_newbcast:2 row_mask:0xf bank_mask:0xf
  v_mfma_f32_16x16x32_bf16 v[40:43], v[124:127], v[48:51], v[40:43]
  s_waitcnt vmcnt(4)
  buffer_load_dwordx4 v[148:151], v2, s[36:39], s41 offen offset:1024 nt
  v_and_b32_dpp v48, v32, v4 row_newbcast:6 row_mask:0xf bank_mask:0xf
  v_and_b32_dpp v49, v32, v5 row_newbcast:6 row_mask:0xf bank_mask:0xf
  v_and_b32_dpp v50, v32, v6 row_newbcast:6 row_mask:0xf bank_mask:0xf
  v_and_b32_dpp v51, v32, v7 row_newbcast:6 row_mask:0xf bank_mask:0xf
  v_mfma_f32_16x16x32_bf16 v[40:43], v[128:131], v[44:47], v[40:43]
  s_waitcnt vmcnt(4)
  buffer_load_dwordx4 v[152:155], v2, s[36:39], s41 offen offset:2048 nt
  v_and_b32_dpp v44, v32, v4 row_newbcast:10 row_mask:0xf bank_mask:0xf
  v_and_b32_dpp v45, v32, v5 row_newbcast:10 row_mask:0xf bank_mask:0xf
  v_and_b32_dpp v46, v32, v6 row_newbcast:10 row_mask:0xf bank_mask:0xf
  v_and_b32_dpp v47, v32, v7 row_newbcast:10 row_mask:0xf bank_mask:0xf
  v_mfma_f32_16x16x32_bf16 v[40:43], v[132:135], v[48:51], v[40:43]
  s_waitcnt vmcnt(4)
  buffer_load_dwordx4 v[156:159], v2, s[36:39], s41 offen offset:3072 nt
  v_and_b32_dpp v48, v32, v4 row_newbcast:14 row_mask:0xf bank_mask:0xf
  v_and_b32_dpp v49, v32, v5 row_newbcast:14 row_mask:0xf bank_mask:0xf
  v_and_b32_dpp v50, v32, v6 row_newbcast:14 row_mask:0xf bank_mask:0xf
  v_and_b32_dpp v51, v32, v7 row_newbcast:14 row_mask:0xf bank_mask:0xf
  v_mfma_f32_16x16x32_bf16 v[40:43], v[136:139], v[44:47], v[40:43]
  s_waitcnt vmcnt(4)
  s_add_u32 s41, s41, 0x4000
  buffer_load_dwordx4 v[160:163], v2, s[36:39], s41 offen offset:0 nt
  v_and_b32_dpp v44, v32, v4 row_newbcast:3 row_mask:0xf bank_mask:0xf
  v_and_b32_dpp v45, v32, v5 row_newbcast:3 row_mask:0xf bank_mask:0xf
  v_and_b32_dpp v46, v32, v6 row_newbcast:3 row_mask:0xf bank_mask:0xf
  v_and_b32_dpp v47, v32, v7 row_newbcast:3 row_mask:0xf bank_mask:0xf
  v_mfma_f32_16x16x32_bf16 v[40:43], v[140:143], v[48:51], v[40:43]
  s_waitcnt vmcnt(4)
  buffer_load_dwordx4 v[164:167], v2, s[36:39], s41 offen offset:1024 nt
  v_and_b32_dpp v48, v32, v4 row_newbcast:7 row_mask:0xf bank_mask:0xf
  v_and_b32_dpp v49, v32, v5 row_newbcast:7 row_mask:0xf bank_mask:0xf
  v_and_b32_dpp v50, v32, v6 row_newbcast:7 row_mask:0xf bank_mask:0xf
  v_and_b32_dpp v51, v32, v7 row_newbcast:7 row_mask:0xf bank_mask:0xf
  v_mfma_f32_16x16x32_bf16 v[40:43], v[144:147], v[44:47], v[40:43]
  s_waitcnt vmcnt(4)
  buffer_load_dwordx4 v[168:171], v2, s[36:39], s41 offen offset:2048 nt
  v_and_b32_dpp v44, v32, v4 row_newbcast:11 row_mask:0xf bank_mask:0xf
  v_and_b32_dpp v45, v32, v5 row_newbcast:11 row_mask:0xf bank_mask:0xf
  v_and_b32_dpp v46, v32, v6 row_newbcast:11 row_mask:0xf bank_mask:0xf
  v_and_b32_dpp v47, v32, v7 row_newbcast:11 row_mask:0xf bank_mask:0xf
  v_mfma_f32_16x16x32_bf16 v[40:43], v[148:151], v[48:51], v[40:43]
  s_waitcnt vmcnt(4)
  buffer_load_dwordx4 v[172:175], v2, s[36:39], s41 offen offset:3072 nt
  v_and_b32_dpp v48, v32, v4 row_newbcast:15 row_mask:0xf bank_mask:0xf
  v_and_b32_dpp v49, v32, v5 row_newbcast:15 row_mask:0xf bank_mask:0xf
  v_and_b32_dpp v50, v32, v6 row_newbcast:15 row_mask:0xf bank_mask:0xf
  v_and_b32_dpp v51, v32, v7 row_newbcast:15 row_mask:0xf bank_mask:0xf
  v_mfma_f32_16x16x32_bf16 v[40:43], v[152:155], v[44:47], v[40:43]
  s_waitcnt vmcnt(4)
  s_add_u32 s41, s41, 0x4000
  buffer_load_dwordx4 v[176:179], v2, s[36:39], s41 offen offset:0 nt
  v_and_b32_dpp v44, v33, v4 row_newbcast:0 row_mask:0xf bank_mask:0xf
  v_and_b32_dpp v45, v33, v5 row_newbcast:0 row_mask:0xf bank_mask:0xf
  v_and_b32_dpp v46, v33, v6 row_newbcast:0 row_mask:0xf bank_mask:0xf
  v_and_b32_dpp v47, v33, v7 row_newbcast:0 row_mask:0xf bank_mask:0xf
  v_mfma_f32_16x16x32_bf16 v[40:43], v[156:159], v[48:51], v[40:43]
  s_waitcnt vmcnt(4)
  buffer_load_dwordx4 v[180:183], v2, s[36:39], s41 offen offset:1024 nt
  v_and_b32_dpp v48, v33, v4 row_newbcast:4 row_mask:0xf bank_mask:0xf
  v_and_b32_dpp v49, v33, v5 row_newbcast:4 row_mask:0xf bank_mask:0xf
  v_and_b32_dpp v50, v33, v6 row_newbcast:4 row_mask:0xf bank_mask:0xf
  v_and_b32_dpp v51, v33, v7 row_newbcast:4 row_mask:0xf bank_mask:0xf
  v_mfma_f32_16x16x32_bf16 v[40:43], v[160:163], v[44:47], v[40:43]
  s_waitcnt vmcnt(4)
  buffer_load_dwordx4 v[184:187], v2, s[36:39], s41 offen offset:2048 nt
  v_and_b32_dpp v44, v33, v4 row_newbcast:8 row_mask:0xf bank_mask:0xf
  v_and_b32_dpp v45, v33, v5 row_newbcast:8 row_mask:0xf bank_mask:0xf
  v_and_b32_dpp v46, v33, v6 row_newbcast:8 row_mask:0xf bank_mask:0xf
  v_and_b32_dpp v47, v33, v7 row_newbcast:8 row_mask:0xf bank_mask:0xf
  v_mfma_f32_16x16x32_bf16 v[40:43], v[164:167], v[48:51], v[40:43]
  s_waitcnt vmcnt(4)
  buffer_load_dwordx4 v[188:191], v2, s[36:39], s41 offen offset:3072 nt
  v_and_b32_dpp v48, v33, v4 row_newbcast:12 row_mask:0xf bank_mask:0xf
  v_and_b32_dpp v49, v33, v5 row_newbcast:12 row_mask:0xf bank_mask:0xf
  v_and_b32_dpp v50, v33, v6 row_newbcast:12 row_mask:0xf bank_mask:0xf
  v_and_b32_dpp v51, v33, v7 row_newbcast:12 row_mask:0xf bank_mask:0xf
  v_mfma_f32_16x16x32_bf16 v[40:43], v[168:171], v[44:47], v[40:43]
  s_waitcnt vmcnt(4)
  s_add_u32 s41, s41, 0x4000
  buffer_load_dwordx4 v[192:195], v2, s[36:39], s41 offen offset:0 nt
  v_and_b32_dpp v44, v33, v4 row_newbcast:1 row_mask:0xf bank_mask:0xf
  v_and_b32_dpp v45, v33, v5 row_newbcast:1 row_mask:0xf bank_mask:0xf
  v_and_b32_dpp v46, v33, v6 row_newbcast:1 row_mask:0xf bank_mask:0xf
  v_and_b32_dpp v47, v33, v7 row_newbcast:1 row_mask:0xf bank_mask:0xf
  v_mfma_f32_16x16x32_bf16 v[40:43], v[172:175], v[48:51], v[40:43]
  s_waitcnt vmcnt(4)
  buffer_load_dwordx4 v[196:199], v2, s[36:39], s41 offen offset:1024 nt
  v_and_b32_dpp v48, v33, v4 row_newbcast:5 row_mask:0xf bank_mask:0xf
  v_and_b32_dpp v49, v33, v5 row_newbcast:5 row_mask:0xf bank_mask:0xf
  v_and_b32_dpp v50, v33, v6 row_newbcast:5 row_mask:0xf bank_mask:0xf
  v_and_b32_dpp v51, v33, v7 row_newbcast:5 row_mask:0xf bank_mask:0xf
  v_mfma_f32_16x16x32_bf16 v[40:43], v[176:179], v[44:47], v[40:43]
  s_waitcnt vmcnt(4)
  buffer_load_dwordx4 v[200:203], v2, s[36:39], s41 offen offset:2048 nt
  v_and_b32_dpp v44, v33, v4 row_newbcast:9 row_mask:0xf bank_mask:0xf
  v_and_b32_dpp v45, v33, v5 row_newbcast:9 row_mask:0xf bank_mask:0xf
  v_and_b32_dpp v46, v33, v6 row_newbcast:9 row_mask:0xf bank_mask:0xf
  v_and_b32_dpp v47, v33, v7 row_newbcast:9 row_mask:0xf bank_mask:0xf
  v_mfma_f32_16x16x32_bf16 v[40:43], v[180:183], v[48:51], v[40:43]
  s_waitcnt vmcnt(4)
  buffer_load_dwordx4 v[204:207], v2, s[36:39], s41 offen offset:3072 nt
  v_and_b32_dpp v48, v33, v4 row_newbcast:13 row_mask:0xf bank_mask:0xf
  v_and_b32_dpp v49, v33, v5 row_newbcast:13 row_mask:0xf bank_mask:0xf
  v_and_b32_dpp v50, v33, v6 row_newbcast:13 row_mask:0xf bank_mask:0xf
  v_and_b32_dpp v51, v33, v7 row_newbcast:13 row_mask:0xf bank_mask:0xf
  v_mfma_f32_16x16x32_bf16 v[40:43], v[184:187], v[44:47], v[40:43]
  s_waitcnt vmcnt(4)
  s_add_u32 s41, s41, 0x4000
  buffer_load_dwordx4 v[208:211], v2, s[36:39], s41 offen offset:0 nt
  v_and_b32_dpp v44, v33, v4 row_newbcast:2 row_mask:0xf bank_mask:0xf
  v_and_b32_dpp v45, v33, v5 row_newbcast:2 row_mask:0xf bank_mask:0xf
  v_and_b32_dpp v46, v33, v6 row_newbcast:2 row_mask:0xf bank_mask:0xf
  v_and_b32_dpp v47, v33, v7 row_newbcast:2 row_mask:0xf bank_mask:0xf
  v_mfma_f32_16x16x32_bf16 v[40:43], v[188:191], v[48:51], v[40:43]
  s_waitcnt vmcnt(4)
  buffer_load_dwordx4 v[212:215], v2, s[36:39], s41 offen offset:1024 nt
  v_and_b32_dpp v48, v33, v4 row_newbcast:6 row_mask:0xf bank_mask:0xf
  v_and_b32_dpp v49, v33, v5 row_newbcast:6 row_mask:0xf bank_mask:0xf
  v_and_b32_dpp v50, v33, v6 row_newbcast:6 row_mask:0xf bank_mask:0xf
  v_and_b32_dpp v51, v33, v7 row_newbcast:6 row_mask:0xf bank_mask:0xf
  v_mfma_f32_16x16x32_bf16 v[40:43], v[192:195], v[44:47], v[40:43]
  s_waitcnt vmcnt(4)
  buffer_load_dwordx4 v[216:219], v2, s[36:39], s41 offen offset:2048 nt
  v_and_b32_dpp v44, v33, v4 row_newbcast:10 row_mask:0xf bank_mask:0xf
  v_and_b32_dpp v45, v33, v5 row_newbcast:10 row_mask:0xf bank_mask:0xf
  v_and_b32_dpp v46, v33, v6 row_newbcast:10 row_mask:0xf bank_mask:0xf
  v_and_b32_dpp v47, v33, v7 row_newbcast:10 row_mask:0xf bank_mask:0xf
  v_mfma_f32_16x16x32_bf16 v[40:43], v[196:199], v[48:51], v[40:43]
  s_waitcnt vmcnt(4)
  buffer_load_dwordx4 v[220:223], v2, s[36:39], s41 offen offset:3072 nt
  v_and_b32_dpp v48, v33, v4 row_newbcast:14 row_mask:0xf bank_mask:0xf
  v_and_b32_dpp v49, v33, v5 row_newbcast:14 row_mask:0xf bank_mask:0xf
  v_and_b32_dpp v50, v33, v6 row_newbcast:14 row_mask:0xf bank_mask:0xf
  v_and_b32_dpp v51, v33, v7 row_newbcast:14 row_mask:0xf bank_mask:0xf
  v_mfma_f32_16x16x32_bf16 v[40:43], v[200:203], v[44:47], v[40:43]
  s_waitcnt vmcnt(4)
  s_add_u32 s41, s41, 0x4000
  buffer_load_dwordx4 v[64:67], v2, s[36:39], s41 offen offset:0 nt
  v_and_b32_dpp v44, v33, v4 row_newbcast:3 row_mask:0xf bank_mask:0xf
  v_and_b32_dpp v45, v33, v5 row_newbcast:3 row_mask:0xf bank_mask:0xf
  v_and_b32_dpp v46, v33, v6 row_newbcast:3 row_mask:0xf bank_mask:0xf
  v_and_b32_dpp v47, v33, v7 row_newbcast:3 row_mask:0xf bank_mask:0xf
  v_mfma_f32_16x16x32_bf16 v[40:43], v[204:207], v[48:51], v[40:43]
  s_waitcnt vmcnt(4)
  buffer_load_dwordx4 v[68:71], v2, s[36:39], s41 offen offset:1024 nt
  v_and_b32_dpp v48, v33, v4 row_newbcast:7 row_mask:0xf bank_mask:0xf
  v_and_b32_dpp v49, v33, v5 row_newbcast:7 row_mask:0xf bank_mask:0xf
  v_and_b32_dpp v50, v33, v6 row_newbcast:7 row_mask:0xf bank_mask:0xf
  v_and_b32_dpp v51, v33, v7 row_newbcast:7 row_mask:0xf bank_mask:0xf
  v_mfma_f32_16x16x32_bf16 v[40:43], v[208:211], v[44:47], v[40:43]
  s_waitcnt vmcnt(4)
  buffer_load_dwordx4 v[72:75], v2, s[36:39], s41 offen offset:2048 nt
  v_and_b32_dpp v44, v33, v4 row_newbcast:11 row_mask:0xf bank_mask:0xf
  v_and_b32_dpp v45, v33, v5 row_newbcast:11 row_mask:0xf bank_mask:0xf
  v_and_b32_dpp v46, v33, v6 row_newbcast:11 row_mask:0xf bank_mask:0xf
  v_and_b32_dpp v47, v33, v7 row_newbcast:11 row_mask:0xf bank_mask:0xf
  v_mfma_f32_16x16x32_bf16 v[40:43], v[212:215], v[48:51], v[40:43]
  s_waitcnt vmcnt(4)
  buffer_load_dwordx4 v[76:79], v2, s[36:39], s41 offen offset:3072 nt
  v_and_b32_dpp v48, v33, v4 row_newbcast:15 row_mask:0xf bank_mask:0xf
  v_and_b32_dpp v49, v33, v5 row_newbcast:15 row_mask:0xf bank_mask:0xf
  v_and_b32_dpp v50, v33, v6 row_newbcast:15 row_mask:0xf bank_mask:0xf
  v_and_b32_dpp v51, v33, v7 row_newbcast:15 row_mask:0xf bank_mask:0xf
  v_mfma_f32_16x16x32_bf16 v[40:43], v[216:219], v[44:47], v[40:43]
  s_waitcnt vmcnt(4)
  s_add_u32 s41, s41, 0x4000
  buffer_load_dwordx4 v[80:83], v2, s[36:39], s41 offen offset:0 nt
  v_and_b32_dpp v44, v34, v4 row_newbcast:0 row_mask:0xf bank_mask:0xf
  v_and_b32_dpp v45, v34, v5 row_newbcast:0 row_mask:0xf bank_mask:0xf
  v_and_b32_dpp v46, v34, v6 row_newbcast:0 row_mask:0xf bank_mask:0xf
  v_and_b32_dpp v47, v34, v7 row_newbcast:0 row_mask:0xf bank_mask:0xf
  v_mfma_f32_16x16x32_bf16 v[40:43], v[220:223], v[48:51], v[40:43]
  s_waitcnt vmcnt(4)
  buffer_load_dwordx4 v[84:87], v2, s[36:39], s41 offen offset:1024 nt
  v_and_b32_dpp v48, v34, v4 row_newbcast:4 row_mask:0xf bank_mask:0xf
  v_and_b32_dpp v49, v34, v5 row_newbcast:4 row_mask:0xf bank_mask:0xf
  v_and_b32_dpp v50, v34, v6 row_newbcast:4 row_mask:0xf bank_mask:0xf
  v_and_b32_dpp v51, v34, v7 row_newbcast:4 row_mask:0xf bank_mask:0xf
  v_mfma_f32_16x16x32_bf16 v[40:43], v[64:67], v[44:47], v[40:43]
  s_waitcnt vmcnt(4)
  buffer_load_dwordx4 v[88:91], v2, s[36:39], s41 offen offset:2048 nt
  v_and_b32_dpp v44, v34, v4 row_newbcast:8 row_mask:0xf bank_mask:0xf
  v_and_b32_dpp v45, v34, v5 row_newbcast:8 row_mask:0xf bank_mask:0xf
  v_and_b32_dpp v46, v34, v6 row_newbcast:8 row_mask:0xf bank_mask:0xf
  v_and_b32_dpp v47, v34, v7 row_newbcast:8 row_mask:0xf bank_mask:0xf
  v_mfma_f32_16x16x32_bf16 v[40:43], v[68:71], v[48:51], v[40:43]
  s_waitcnt vmcnt(4)
  buffer_load_dwordx4 v[92:95], v2, s[36:39], s41 offen offset:3072 nt
  v_and_b32_dpp v48, v34, v4 row_newbcast:12 row_mask:0xf bank_mask:0xf
  v_and_b32_dpp v49, v34, v5 row_newbcast:12 row_mask:0xf bank_mask:0xf
  v_and_b32_dpp v50, v34, v6 row_newbcast:12 row_mask:0xf bank_mask:0xf
  v_and_b32_dpp v51, v34, v7 row_newbcast:12 row_mask:0xf bank_mask:0xf
  v_mfma_f32_16x16x32_bf16 v[40:43], v[72:75], v[44:47], v[40:43]
  s_waitcnt vmcnt(4)
  s_add_u32 s41, s41, 0x4000
  buffer_load_dwordx4 v[96:99], v2, s[36:39], s41 offen offset:0 nt
  v_and_b32_dpp v44, v34, v4 row_newbcast:1 row_mask:0xf bank_mask:0xf
  v_and_b32_dpp v45, v34, v5 row_newbcast:1 row_mask:0xf bank_mask:0xf
  v_and_b32_dpp v46, v34, v6 row_newbcast:1 row_mask:0xf bank_mask:0xf
  v_and_b32_dpp v47, v34, v7 row_newbcast:1 row_mask:0xf bank_mask:0xf
  v_mfma_f32_16x16x32_bf16 v[40:43], v[76:79], v[48:51], v[40:43]
  s_waitcnt vmcnt(4)
  buffer_load_dwordx4 v[100:103], v2, s[36:39], s41 offen offset:1024 nt
  v_and_b32_dpp v48, v34, v4 row_newbcast:5 row_mask:0xf bank_mask:0xf
  v_and_b32_dpp v49, v34, v5 row_newbcast:5 row_mask:0xf bank_mask:0xf
  v_and_b32_dpp v50, v34, v6 row_newbcast:5 row_mask:0xf bank_mask:0xf
  v_and_b32_dpp v51, v34, v7 row_newbcast:5 row_mask:0xf bank_mask:0xf
  v_mfma_f32_16x16x32_bf16 v[40:43], v[80:83], v[44:47], v[40:43]
  s_waitcnt vmcnt(4)
  buffer_load_dwordx4 v[104:107], v2, s[36:39], s41 offen offset:2048 nt
  v_and_b32_dpp v44, v34, v4 row_newbcast:9 row_mask:0xf bank_mask:0xf
  v_and_b32_dpp v45, v34, v5 row_newbcast:9 row_mask:0xf bank_mask:0xf
  v_and_b32_dpp v46, v34, v6 row_newbcast:9 row_mask:0xf bank_mask:0xf
  v_and_b32_dpp v47, v34, v7 row_newbcast:9 row_mask:0xf bank_mask:0xf
  v_mfma_f32_16x16x32_bf16 v[40:43], v[84:87], v[48:51], v[40:43]
  s_waitcnt vmcnt(4)
  buffer_load_dwordx4 v[108:111], v2, s[36:39], s41 offen offset:3072 nt
  v_and_b32_dpp v48, v34, v4 row_newbcast:13 row_mask:0xf bank_mask:0xf
  v_and_b32_dpp v49, v34, v5 row_newbcast:13 row_mask:0xf bank_mask:0xf
  v_and_b32_dpp v50, v34, v6 row_newbcast:13 row_mask:0xf bank_mask:0xf
  v_and_b32_dpp v51, v34, v7 row_newbcast:13 row_mask:0xf bank_mask:0xf
  v_mfma_f32_16x16x32_bf16 v[40:43], v[88:91], v[44:47], v[40:43]
  s_waitcnt vmcnt(4)
  s_add_u32 s41, s41, 0x4000
  buffer_load_dwordx4 v[112:115], v2, s[36:39], s41 offen offset:0 nt
  v_and_b32_dpp v44, v34, v4 row_newbcast:2 row_mask:0xf bank_mask:0xf
  v_and_b32_dpp v45, v34, v5 row_newbcast:2 row_mask:0xf bank_mask:0xf
  v_and_b32_dpp v46, v34, v6 row_newbcast:2 row_mask:0xf bank_mask:0xf
  v_and_b32_dpp v47, v34, v7 row_newbcast:2 row_mask:0xf bank_mask:0xf
  v_mfma_f32_16x16x32_bf16 v[40:43], v[92:95], v[48:51], v[40:43]
  s_waitcnt vmcnt(4)
  buffer_load_dwordx4 v[116:119], v2, s[36:39], s41 offen offset:1024 nt
  v_and_b32_dpp v48, v34, v4 row_newbcast:6 row_mask:0xf bank_mask:0xf
  v_and_b32_dpp v49, v34, v5 row_newbcast:6 row_mask:0xf bank_mask:0xf
  v_and_b32_dpp v50, v34, v6 row_newbcast:6 row_mask:0xf bank_mask:0xf
  v_and_b32_dpp v51, v34, v7 row_newbcast:6 row_mask:0xf bank_mask:0xf
  v_mfma_f32_16x16x32_bf16 v[40:43], v[96:99], v[44:47], v[40:43]
  s_waitcnt vmcnt(4)
  buffer_load_dwordx4 v[120:123], v2, s[36:39], s41 offen offset:2048 nt
  v_and_b32_dpp v44, v34, v4 row_newbcast:10 row_mask:0xf bank_mask:0xf
  v_and_b32_dpp v45, v34, v5 row_newbcast:10 row_mask:0xf bank_mask:0xf
  v_and_b32_dpp v46, v34, v6 row_newbcast:10 row_mask:0xf bank_mask:0xf
  v_and_b32_dpp v47, v34, v7 row_newbcast:10 row_mask:0xf bank_mask:0xf
  v_mfma_f32_16x16x32_bf16 v[40:43], v[100:103], v[48:51], v[40:43]
  s_waitcnt vmcnt(4)
  buffer_load_dwordx4 v[124:127], v2, s[36:39], s41 offen offset:3072 nt
  v_and_b32_dpp v48, v34, v4 row_newbcast:14 row_mask:0xf bank_mask:0xf
  v_and_b32_dpp v49, v34, v5 row_newbcast:14 row_mask:0xf bank_mask:0xf
  v_and_b32_dpp v50, v34, v6 row_newbcast:14 row_mask:0xf bank_mask:0xf
  v_and_b32_dpp v51, v34, v7 row_newbcast:14 row_mask:0xf bank_mask:0xf
  v_mfma_f32_16x16x32_bf16 v[40:43], v[104:107], v[44:47], v[40:43]
  s_waitcnt vmcnt(4)
  s_add_u32 s41, s41, 0x4000
  buffer_load_dwordx4 v[128:131], v2, s[36:39], s41 offen offset:0 nt
  v_and_b32_dpp v44, v34, v4 row_newbcast:3 row_mask:0xf bank_mask:0xf
  v_and_b32_dpp v45, v34, v5 row_newbcast:3 row_mask:0xf bank_mask:0xf
  v_and_b32_dpp v46, v34, v6 row_newbcast:3 row_mask:0xf bank_mask:0xf
  v_and_b32_dpp v47, v34, v7 row_newbcast:3 row_mask:0xf bank_mask:0xf
  v_mfma_f32_16x16x32_bf16 v[40:43], v[108:111], v[48:51], v[40:43]
  s_waitcnt vmcnt(4)
  buffer_load_dwordx4 v[132:135], v2, s[36:39], s41 offen offset:1024 nt
  v_and_b32_dpp v48, v34, v4 row_newbcast:7 row_mask:0xf bank_mask:0xf
  v_and_b32_dpp v49, v34, v5 row_newbcast:7 row_mask:0xf bank_mask:0xf
  v_and_b32_dpp v50, v34, v6 row_newbcast:7 row_mask:0xf bank_mask:0xf
  v_and_b32_dpp v51, v34, v7 row_newbcast:7 row_mask:0xf bank_mask:0xf
  v_mfma_f32_16x16x32_bf16 v[40:43], v[112:115], v[44:47], v[40:43]
  s_waitcnt vmcnt(4)
  buffer_load_dwordx4 v[136:139], v2, s[36:39], s41 offen offset:2048 nt
  v_and_b32_dpp v44, v34, v4 row_newbcast:11 row_mask:0xf bank_mask:0xf
  v_and_b32_dpp v45, v34, v5 row_newbcast:11 row_mask:0xf bank_mask:0xf
  v_and_b32_dpp v46, v34, v6 row_newbcast:11 row_mask:0xf bank_mask:0xf
  v_and_b32_dpp v47, v34, v7 row_newbcast:11 row_mask:0xf bank_mask:0xf
  v_mfma_f32_16x16x32_bf16 v[40:43], v[116:119], v[48:51], v[40:43]
  s_waitcnt vmcnt(4)
  buffer_load_dwordx4 v[140:143], v2, s[36:39], s41 offen offset:3072 nt
  v_and_b32_dpp v48, v34, v4 row_newbcast:15 row_mask:0xf bank_mask:0xf
  v_and_b32_dpp v49, v34, v5 row_newbcast:15 row_mask:0xf bank_mask:0xf
  v_and_b32_dpp v50, v34, v6 row_newbcast:15 row_mask:0xf bank_mask:0xf
  v_and_b32_dpp v51, v34, v7 row_newbcast:15 row_mask:0xf bank_mask:0xf
  v_mfma_f32_16x16x32_bf16 v[40:43], v[120:123], v[44:47], v[40:43]
  s_waitcnt vmcnt(4)
  s_add_u32 s41, s41, 0x4000
  buffer_load_dwordx4 v[144:147], v2, s[36:39], s41 offen offset:0 nt
  v_and_b32_dpp v44, v35, v4 row_newbcast:0 row_mask:0xf bank_mask:0xf
  v_and_b32_dpp v45, v35, v5 row_newbcast:0 row_mask:0xf bank_mask:0xf
  v_and_b32_dpp v46, v35, v6 row_newbcast:0 row_mask:0xf bank_mask:0xf
  v_and_b32_dpp v47, v35, v7 row_newbcast:0 row_mask:0xf bank_mask:0xf
  v_mfma_f32_16x16x32_bf16 v[40:43], v[124:127], v[48:51], v[40:43]
  s_waitcnt vmcnt(4)
  buffer_load_dwordx4 v[148:151], v2, s[36:39], s41 offen offset:1024 nt
  v_and_b32_dpp v48, v35, v4 row_newbcast:4 row_mask:0xf bank_mask:0xf
  v_and_b32_dpp v49, v35, v5 row_newbcast:4 row_mask:0xf bank_mask:0xf
  v_and_b32_dpp v50, v35, v6 row_newbcast:4 row_mask:0xf bank_mask:0xf
  v_and_b32_dpp v51, v35, v7 row_newbcast:4 row_mask:0xf bank_mask:0xf
  v_mfma_f32_16x16x32_bf16 v[40:43], v[128:131], v[44:47], v[40:43]
  s_waitcnt vmcnt(4)
  buffer_load_dwordx4 v[152:155], v2, s[36:39], s41 offen offset:2048 nt
  v_and_b32_dpp v44, v35, v4 row_newbcast:8 row_mask:0xf bank_mask:0xf
  v_and_b32_dpp v45, v35, v5 row_newbcast:8 row_mask:0xf bank_mask:0xf
  v_and_b32_dpp v46, v35, v6 row_newbcast:8 row_mask:0xf bank_mask:0xf
  v_and_b32_dpp v47, v35, v7 row_newbcast:8 row_mask:0xf bank_mask:0xf
  v_mfma_f32_16x16x32_bf16 v[40:43], v[132:135], v[48:51], v[40:43]
  s_waitcnt vmcnt(4)
  buffer_load_dwordx4 v[156:159], v2, s[36:39], s41 offen offset:3072 nt
  v_and_b32_dpp v48, v35, v4 row_newbcast:12 row_mask:0xf bank_mask:0xf
  v_and_b32_dpp v49, v35, v5 row_newbcast:12 row_mask:0xf bank_mask:0xf
  v_and_b32_dpp v50, v35, v6 row_newbcast:12 row_mask:0xf bank_mask:0xf
  v_and_b32_dpp v51, v35, v7 row_newbcast:12 row_mask:0xf bank_mask:0xf
  v_mfma_f32_16x16x32_bf16 v[40:43], v[136:139], v[44:47], v[40:43]
  s_waitcnt vmcnt(4)
  s_add_u32 s41, s41, 0x4000
  buffer_load_dwordx4 v[160:163], v2, s[36:39], s41 offen offset:0 nt
  v_and_b32_dpp v44, v35, v4 row_newbcast:1 row_mask:0xf bank_mask:0xf
  v_and_b32_dpp v45, v35, v5 row_newbcast:1 row_mask:0xf bank_mask:0xf
  v_and_b32_dpp v46, v35, v6 row_newbcast:1 row_mask:0xf bank_mask:0xf
  v_and_b32_dpp v47, v35, v7 row_newbcast:1 row_mask:0xf bank_mask:0xf
  v_mfma_f32_16x16x32_bf16 v[40:43], v[140:143], v[48:51], v[40:43]
  s_waitcnt vmcnt(4)
  buffer_load_dwordx4 v[164:167], v2, s[36:39], s41 offen offset:1024 nt
  v_and_b32_dpp v48, v35, v4 row_newbcast:5 row_mask:0xf bank_mask:0xf
  v_and_b32_dpp v49, v35, v5 row_newbcast:5 row_mask:0xf bank_mask:0xf
  v_and_b32_dpp v50, v35, v6 row_newbcast:5 row_mask:0xf bank_mask:0xf
  v_and_b32_dpp v51, v35, v7 row_newbcast:5 row_mask:0xf bank_mask:0xf
  v_mfma_f32_16x16x32_bf16 v[40:43], v[144:147], v[44:47], v[40:43]
  s_waitcnt vmcnt(4)
  buffer_load_dwordx4 v[168:171], v2, s[36:39], s41 offen offset:2048 nt
  v_and_b32_dpp v44, v35, v4 row_newbcast:9 row_mask:0xf bank_mask:0xf
  v_and_b32_dpp v45, v35, v5 row_newbcast:9 row_mask:0xf bank_mask:0xf
  v_and_b32_dpp v46, v35, v6 row_newbcast:9 row_mask:0xf bank_mask:0xf
  v_and_b32_dpp v47, v35, v7 row_newbcast:9 row_mask:0xf bank_mask:0xf
  v_mfma_f32_16x16x32_bf16 v[40:43], v[148:151], v[48:51], v[40:43]
  s_waitcnt vmcnt(4)
  buffer_load_dwordx4 v[172:175], v2, s[36:39], s41 offen offset:3072 nt
  v_and_b32_dpp v48, v35, v4 row_newbcast:13 row_mask:0xf bank_mask:0xf
  v_and_b32_dpp v49, v35, v5 row_newbcast:13 row_mask:0xf bank_mask:0xf
  v_and_b32_dpp v50, v35, v6 row_newbcast:13 row_mask:0xf bank_mask:0xf
  v_and_b32_dpp v51, v35, v7 row_newbcast:13 row_mask:0xf bank_mask:0xf
  v_mfma_f32_16x16x32_bf16 v[40:43], v[152:155], v[44:47], v[40:43]
  s_waitcnt vmcnt(4)
  s_add_u32 s41, s41, 0x4000
  buffer_load_dwordx4 v[176:179], v2, s[36:39], s41 offen offset:0 nt
  v_and_b32_dpp v44, v35, v4 row_newbcast:2 row_mask:0xf bank_mask:0xf
  v_and_b32_dpp v45, v35, v5 row_newbcast:2 row_mask:0xf bank_mask:0xf
  v_and_b32_dpp v46, v35, v6 row_newbcast:2 row_mask:0xf bank_mask:0xf
  v_and_b32_dpp v47, v35, v7 row_newbcast:2 row_mask:0xf bank_mask:0xf
  v_mfma_f32_16x16x32_bf16 v[40:43], v[156:159], v[48:51], v[40:43]
  s_waitcnt vmcnt(4)
  buffer_load_dwordx4 v[180:183], v2, s[36:39], s41 offen offset:1024 nt
  v_and_b32_dpp v48, v35, v4 row_newbcast:6 row_mask:0xf bank_mask:0xf
  v_and_b32_dpp v49, v35, v5 row_newbcast:6 row_mask:0xf bank_mask:0xf
  v_and_b32_dpp v50, v35, v6 row_newbcast:6 row_mask:0xf bank_mask:0xf
  v_and_b32_dpp v51, v35, v7 row_newbcast:6 row_mask:0xf bank_mask:0xf
  v_mfma_f32_16x16x32_bf16 v[40:43], v[160:163], v[44:47], v[40:43]
  s_waitcnt vmcnt(4)
  buffer_load_dwordx4 v[184:187], v2, s[36:39], s41 offen offset:2048 nt
  v_and_b32_dpp v44, v35, v4 row_newbcast:10 row_mask:0xf bank_mask:0xf
  v_and_b32_dpp v45, v35, v5 row_newbcast:10 row_mask:0xf bank_mask:0xf
  v_and_b32_dpp v46, v35, v6 row_newbcast:10 row_mask:0xf bank_mask:0xf
  v_and_b32_dpp v47, v35, v7 row_newbcast:10 row_mask:0xf bank_mask:0xf
  v_mfma_f32_16x16x32_bf16 v[40:43], v[164:167], v[48:51], v[40:43]
  s_waitcnt vmcnt(4)
  buffer_load_dwordx4 v[188:191], v2, s[36:39], s41 offen offset:3072 nt
  v_and_b32_dpp v48, v35, v4 row_newbcast:14 row_mask:0xf bank_mask:0xf
  v_and_b32_dpp v49, v35, v5 row_newbcast:14 row_mask:0xf bank_mask:0xf
  v_and_b32_dpp v50, v35, v6 row_newbcast:14 row_mask:0xf bank_mask:0xf
  v_and_b32_dpp v51, v35, v7 row_newbcast:14 row_mask:0xf bank_mask:0xf
  v_mfma_f32_16x16x32_bf16 v[40:43], v[168:171], v[44:47], v[40:43]
  s_waitcnt vmcnt(4)
  s_add_u32 s41, s41, 0x4000
  buffer_load_dwordx4 v[192:195], v2, s[36:39], s41 offen offset:0 nt
  v_and_b32_dpp v44, v35, v4 row_newbcast:3 row_mask:0xf bank_mask:0xf
  v_and_b32_dpp v45, v35, v5 row_newbcast:3 row_mask:0xf bank_mask:0xf
  v_and_b32_dpp v46, v35, v6 row_newbcast:3 row_mask:0xf bank_mask:0xf
  v_and_b32_dpp v47, v35, v7 row_newbcast:3 row_mask:0xf bank_mask:0xf
  v_mfma_f32_16x16x32_bf16 v[40:43], v[172:175], v[48:51], v[40:43]
  s_waitcnt vmcnt(4)
  buffer_load_dwordx4 v[196:199], v2, s[36:39], s41 offen offset:1024 nt
  v_and_b32_dpp v48, v35, v4 row_newbcast:7 row_mask:0xf bank_mask:0xf
  v_and_b32_dpp v49, v35, v5 row_newbcast:7 row_mask:0xf bank_mask:0xf
  v_and_b32_dpp v50, v35, v6 row_newbcast:7 row_mask:0xf bank_mask:0xf
  v_and_b32_dpp v51, v35, v7 row_newbcast:7 row_mask:0xf bank_mask:0xf
  v_mfma_f32_16x16x32_bf16 v[40:43], v[176:179], v[44:47], v[40:43]
  s_waitcnt vmcnt(4)
  buffer_load_dwordx4 v[200:203], v2, s[36:39], s41 offen offset:2048 nt
  v_and_b32_dpp v44, v35, v4 row_newbcast:11 row_mask:0xf bank_mask:0xf
  v_and_b32_dpp v45, v35, v5 row_newbcast:11 row_mask:0xf bank_mask:0xf
  v_and_b32_dpp v46, v35, v6 row_newbcast:11 row_mask:0xf bank_mask:0xf
  v_and_b32_dpp v47, v35, v7 row_newbcast:11 row_mask:0xf bank_mask:0xf
  v_mfma_f32_16x16x32_bf16 v[40:43], v[180:183], v[48:51], v[40:43]
  s_waitcnt vmcnt(4)
  buffer_load_dwordx4 v[204:207], v2, s[36:39], s41 offen offset:3072 nt
  v_and_b32_dpp v48, v35, v4 row_newbcast:15 row_mask:0xf bank_mask:0xf
  v_and_b32_dpp v49, v35, v5 row_newbcast:15 row_mask:0xf bank_mask:0xf
  v_and_b32_dpp v50, v35, v6 row_newbcast:15 row_mask:0xf bank_mask:0xf
  v_and_b32_dpp v51, v35, v7 row_newbcast:15 row_mask:0xf bank_mask:0xf
  v_mfma_f32_16x16x32_bf16 v[40:43], v[184:187], v[44:47], v[40:43]
  s_waitcnt vmcnt(4)
  s_add_u32 s41, s41, 0x4000
  buffer_load_dwordx4 v[208:211], v2, s[36:39], s41 offen offset:0 nt
  v_and_b32_dpp v44, v36, v4 row_newbcast:0 row_mask:0xf bank_mask:0xf
  v_and_b32_dpp v45, v36, v5 row_newbcast:0 row_mask:0xf bank_mask:0xf
  v_and_b32_dpp v46, v36, v6 row_newbcast:0 row_mask:0xf bank_mask:0xf
  v_and_b32_dpp v47, v36, v7 row_newbcast:0 row_mask:0xf bank_mask:0xf
  v_mfma_f32_16x16x32_bf16 v[40:43], v[188:191], v[48:51], v[40:43]
  s_waitcnt vmcnt(4)
  buffer_load_dwordx4 v[212:215], v2, s[36:39], s41 offen offset:1024 nt
  v_and_b32_dpp v48, v36, v4 row_newbcast:4 row_mask:0xf bank_mask:0xf
  v_and_b32_dpp v49, v36, v5 row_newbcast:4 row_mask:0xf bank_mask:0xf
  v_and_b32_dpp v50, v36, v6 row_newbcast:4 row_mask:0xf bank_mask:0xf
  v_and_b32_dpp v51, v36, v7 row_newbcast:4 row_mask:0xf bank_mask:0xf
  v_mfma_f32_16x16x32_bf16 v[40:43], v[192:195], v[44:47], v[40:43]
  s_waitcnt vmcnt(4)
  buffer_load_dwordx4 v[216:219], v2, s[36:39], s41 offen offset:2048 nt
  v_and_b32_dpp v44, v36, v4 row_newbcast:8 row_mask:0xf bank_mask:0xf
  v_and_b32_dpp v45, v36, v5 row_newbcast:8 row_mask:0xf bank_mask:0xf
  v_and_b32_dpp v46, v36, v6 row_newbcast:8 row_mask:0xf bank_mask:0xf
  v_and_b32_dpp v47, v36, v7 row_newbcast:8 row_mask:0xf bank_mask:0xf
  v_mfma_f32_16x16x32_bf16 v[40:43], v[196:199], v[48:51], v[40:43]
  s_waitcnt vmcnt(4)
  buffer_load_dwordx4 v[220:223], v2, s[36:39], s41 offen offset:3072 nt
  v_and_b32_dpp v48, v36, v4 row_newbcast:12 row_mask:0xf bank_mask:0xf
  v_and_b32_dpp v49, v36, v5 row_newbcast:12 row_mask:0xf bank_mask:0xf
  v_and_b32_dpp v50, v36, v6 row_newbcast:12 row_mask:0xf bank_mask:0xf
  v_and_b32_dpp v51, v36, v7 row_newbcast:12 row_mask:0xf bank_mask:0xf
  v_mfma_f32_16x16x32_bf16 v[40:43], v[200:203], v[44:47], v[40:43]
  s_waitcnt vmcnt(4)
  s_add_u32 s41, s41, 0x4000
  buffer_load_dwordx4 v[64:67], v2, s[36:39], s41 offen offset:0 nt
  v_and_b32_dpp v44, v36, v4 row_newbcast:1 row_mask:0xf bank_mask:0xf
  v_and_b32_dpp v45, v36, v5 row_newbcast:1 row_mask:0xf bank_mask:0xf
  v_and_b32_dpp v46, v36, v6 row_newbcast:1 row_mask:0xf bank_mask:0xf
  v_and_b32_dpp v47, v36, v7 row_newbcast:1 row_mask:0xf bank_mask:0xf
  v_mfma_f32_16x16x32_bf16 v[40:43], v[204:207], v[48:51], v[40:43]
  s_waitcnt vmcnt(4)
  buffer_load_dwordx4 v[68:71], v2, s[36:39], s41 offen offset:1024 nt
  v_and_b32_dpp v48, v36, v4 row_newbcast:5 row_mask:0xf bank_mask:0xf
  v_and_b32_dpp v49, v36, v5 row_newbcast:5 row_mask:0xf bank_mask:0xf
  v_and_b32_dpp v50, v36, v6 row_newbcast:5 row_mask:0xf bank_mask:0xf
  v_and_b32_dpp v51, v36, v7 row_newbcast:5 row_mask:0xf bank_mask:0xf
  v_mfma_f32_16x16x32_bf16 v[40:43], v[208:211], v[44:47], v[40:43]
  s_waitcnt vmcnt(4)
  buffer_load_dwordx4 v[72:75], v2, s[36:39], s41 offen offset:2048 nt
  v_and_b32_dpp v44, v36, v4 row_newbcast:9 row_mask:0xf bank_mask:0xf
  v_and_b32_dpp v45, v36, v5 row_newbcast:9 row_mask:0xf bank_mask:0xf
  v_and_b32_dpp v46, v36, v6 row_newbcast:9 row_mask:0xf bank_mask:0xf
  v_and_b32_dpp v47, v36, v7 row_newbcast:9 row_mask:0xf bank_mask:0xf
  v_mfma_f32_16x16x32_bf16 v[40:43], v[212:215], v[48:51], v[40:43]
  s_waitcnt vmcnt(4)
  buffer_load_dwordx4 v[76:79], v2, s[36:39], s41 offen offset:3072 nt
  v_and_b32_dpp v48, v36, v4 row_newbcast:13 row_mask:0xf bank_mask:0xf
  v_and_b32_dpp v49, v36, v5 row_newbcast:13 row_mask:0xf bank_mask:0xf
  v_and_b32_dpp v50, v36, v6 row_newbcast:13 row_mask:0xf bank_mask:0xf
  v_and_b32_dpp v51, v36, v7 row_newbcast:13 row_mask:0xf bank_mask:0xf
  v_mfma_f32_16x16x32_bf16 v[40:43], v[216:219], v[44:47], v[40:43]
  s_waitcnt vmcnt(4)
  s_add_u32 s41, s41, 0x4000
  buffer_load_dwordx4 v[80:83], v2, s[36:39], s41 offen offset:0 nt
  v_and_b32_dpp v44, v36, v4 row_newbcast:2 row_mask:0xf bank_mask:0xf
  v_and_b32_dpp v45, v36, v5 row_newbcast:2 row_mask:0xf bank_mask:0xf
  v_and_b32_dpp v46, v36, v6 row_newbcast:2 row_mask:0xf bank_mask:0xf
  v_and_b32_dpp v47, v36, v7 row_newbcast:2 row_mask:0xf bank_mask:0xf
  v_mfma_f32_16x16x32_bf16 v[40:43], v[220:223], v[48:51], v[40:43]
  s_waitcnt vmcnt(4)
  buffer_load_dwordx4 v[84:87], v2, s[36:39], s41 offen offset:1024 nt
  v_and_b32_dpp v48, v36, v4 row_newbcast:6 row_mask:0xf bank_mask:0xf
  v_and_b32_dpp v49, v36, v5 row_newbcast:6 row_mask:0xf bank_mask:0xf
  v_and_b32_dpp v50, v36, v6 row_newbcast:6 row_mask:0xf bank_mask:0xf
  v_and_b32_dpp v51, v36, v7 row_newbcast:6 row_mask:0xf bank_mask:0xf
  v_mfma_f32_16x16x32_bf16 v[40:43], v[64:67], v[44:47], v[40:43]
  s_waitcnt vmcnt(4)
  buffer_load_dwordx4 v[88:91], v2, s[36:39], s41 offen offset:2048 nt
  v_and_b32_dpp v44, v36, v4 row_newbcast:10 row_mask:0xf bank_mask:0xf
  v_and_b32_dpp v45, v36, v5 row_newbcast:10 row_mask:0xf bank_mask:0xf
  v_and_b32_dpp v46, v36, v6 row_newbcast:10 row_mask:0xf bank_mask:0xf
  v_and_b32_dpp v47, v36, v7 row_newbcast:10 row_mask:0xf bank_mask:0xf
  v_mfma_f32_16x16x32_bf16 v[40:43], v[68:71], v[48:51], v[40:43]
  s_waitcnt vmcnt(4)
  buffer_load_dwordx4 v[92:95], v2, s[36:39], s41 offen offset:3072 nt
  v_and_b32_dpp v48, v36, v4 row_newbcast:14 row_mask:0xf bank_mask:0xf
  v_and_b32_dpp v49, v36, v5 row_newbcast:14 row_mask:0xf bank_mask:0xf
  v_and_b32_dpp v50, v36, v6 row_newbcast:14 row_mask:0xf bank_mask:0xf
  v_and_b32_dpp v51, v36, v7 row_newbcast:14 row_mask:0xf bank_mask:0xf
  v_mfma_f32_16x16x32_bf16 v[40:43], v[72:75], v[44:47], v[40:43]
  s_waitcnt vmcnt(4)
  s_add_u32 s41, s41, 0x4000
  buffer_load_dwordx4 v[96:99], v2, s[36:39], s41 offen offset:0 nt
  v_and_b32_dpp v44, v36, v4 row_newbcast:3 row_mask:0xf bank_mask:0xf
  v_and_b32_dpp v45, v36, v5 row_newbcast:3 row_mask:0xf bank_mask:0xf
  v_and_b32_dpp v46, v36, v6 row_newbcast:3 row_mask:0xf bank_mask:0xf
  v_and_b32_dpp v47, v36, v7 row_newbcast:3 row_mask:0xf bank_mask:0xf
  v_mfma_f32_16x16x32_bf16 v[40:43], v[76:79], v[48:51], v[40:43]
  s_waitcnt vmcnt(4)
  buffer_load_dwordx4 v[100:103], v2, s[36:39], s41 offen offset:1024 nt
  v_and_b32_dpp v48, v36, v4 row_newbcast:7 row_mask:0xf bank_mask:0xf
  v_and_b32_dpp v49, v36, v5 row_newbcast:7 row_mask:0xf bank_mask:0xf
  v_and_b32_dpp v50, v36, v6 row_newbcast:7 row_mask:0xf bank_mask:0xf
  v_and_b32_dpp v51, v36, v7 row_newbcast:7 row_mask:0xf bank_mask:0xf
  v_mfma_f32_16x16x32_bf16 v[40:43], v[80:83], v[44:47], v[40:43]
  s_waitcnt vmcnt(4)
  buffer_load_dwordx4 v[104:107], v2, s[36:39], s41 offen offset:2048 nt
  v_and_b32_dpp v44, v36, v4 row_newbcast:11 row_mask:0xf bank_mask:0xf
  v_and_b32_dpp v45, v36, v5 row_newbcast:11 row_mask:0xf bank_mask:0xf
  v_and_b32_dpp v46, v36, v6 row_newbcast:11 row_mask:0xf bank_mask:0xf
  v_and_b32_dpp v47, v36, v7 row_newbcast:11 row_mask:0xf bank_mask:0xf
  v_mfma_f32_16x16x32_bf16 v[40:43], v[84:87], v[48:51], v[40:43]
  s_waitcnt vmcnt(4)
  buffer_load_dwordx4 v[108:111], v2, s[36:39], s41 offen offset:3072 nt
  v_and_b32_dpp v48, v36, v4 row_newbcast:15 row_mask:0xf bank_mask:0xf
  v_and_b32_dpp v49, v36, v5 row_newbcast:15 row_mask:0xf bank_mask:0xf
  v_and_b32_dpp v50, v36, v6 row_newbcast:15 row_mask:0xf bank_mask:0xf
  v_and_b32_dpp v51, v36, v7 row_newbcast:15 row_mask:0xf bank_mask:0xf
  v_mfma_f32_16x16x32_bf16 v[40:43], v[88:91], v[44:47], v[40:43]
  s_waitcnt vmcnt(4)
  s_add_u32 s41, s41, 0x4000
  buffer_load_dwordx4 v[112:115], v2, s[36:39], s41 offen offset:0 nt
  v_and_b32_dpp v44, v37, v4 row_newbcast:0 row_mask:0xf bank_mask:0xf
  v_and_b32_dpp v45, v37, v5 row_newbcast:0 row_mask:0xf bank_mask:0xf
  v_and_b32_dpp v46, v37, v6 row_newbcast:0 row_mask:0xf bank_mask:0xf
  v_and_b32_dpp v47, v37, v7 row_newbcast:0 row_mask:0xf bank_mask:0xf
  v_mfma_f32_16x16x32_bf16 v[40:43], v[92:95], v[48:51], v[40:43]
  s_waitcnt vmcnt(4)
  buffer_load_dwordx4 v[116:119], v2, s[36:39], s41 offen offset:1024 nt
  v_and_b32_dpp v48, v37, v4 row_newbcast:4 row_mask:0xf bank_mask:0xf
  v_and_b32_dpp v49, v37, v5 row_newbcast:4 row_mask:0xf bank_mask:0xf
  v_and_b32_dpp v50, v37, v6 row_newbcast:4 row_mask:0xf bank_mask:0xf
  v_and_b32_dpp v51, v37, v7 row_newbcast:4 row_mask:0xf bank_mask:0xf
  v_mfma_f32_16x16x32_bf16 v[40:43], v[96:99], v[44:47], v[40:43]
  s_waitcnt vmcnt(4)
  buffer_load_dwordx4 v[120:123], v2, s[36:39], s41 offen offset:2048 nt
  v_and_b32_dpp v44, v37, v4 row_newbcast:8 row_mask:0xf bank_mask:0xf
  v_and_b32_dpp v45, v37, v5 row_newbcast:8 row_mask:0xf bank_mask:0xf
  v_and_b32_dpp v46, v37, v6 row_newbcast:8 row_mask:0xf bank_mask:0xf
  v_and_b32_dpp v47, v37, v7 row_newbcast:8 row_mask:0xf bank_mask:0xf
  v_mfma_f32_16x16x32_bf16 v[40:43], v[100:103], v[48:51], v[40:43]
  s_waitcnt vmcnt(4)
  buffer_load_dwordx4 v[124:127], v2, s[36:39], s41 offen offset:3072 nt
  v_and_b32_dpp v48, v37, v4 row_newbcast:12 row_mask:0xf bank_mask:0xf
  v_and_b32_dpp v49, v37, v5 row_newbcast:12 row_mask:0xf bank_mask:0xf
  v_and_b32_dpp v50, v37, v6 row_newbcast:12 row_mask:0xf bank_mask:0xf
  v_and_b32_dpp v51, v37, v7 row_newbcast:12 row_mask:0xf bank_mask:0xf
  v_mfma_f32_16x16x32_bf16 v[40:43], v[104:107], v[44:47], v[40:43]
  s_waitcnt vmcnt(4)
  s_add_u32 s41, s41, 0x4000
  buffer_load_dwordx4 v[128:131], v2, s[36:39], s41 offen offset:0 nt
  v_and_b32_dpp v44, v37, v4 row_newbcast:1 row_mask:0xf bank_mask:0xf
  v_and_b32_dpp v45, v37, v5 row_newbcast:1 row_mask:0xf bank_mask:0xf
  v_and_b32_dpp v46, v37, v6 row_newbcast:1 row_mask:0xf bank_mask:0xf
  v_and_b32_dpp v47, v37, v7 row_newbcast:1 row_mask:0xf bank_mask:0xf
  v_mfma_f32_16x16x32_bf16 v[40:43], v[108:111], v[48:51], v[40:43]
  s_waitcnt vmcnt(4)
  buffer_load_dwordx4 v[132:135], v2, s[36:39], s41 offen offset:1024 nt
  v_and_b32_dpp v48, v37, v4 row_newbcast:5 row_mask:0xf bank_mask:0xf
  v_and_b32_dpp v49, v37, v5 row_newbcast:5 row_mask:0xf bank_mask:0xf
  v_and_b32_dpp v50, v37, v6 row_newbcast:5 row_mask:0xf bank_mask:0xf
  v_and_b32_dpp v51, v37, v7 row_newbcast:5 row_mask:0xf bank_mask:0xf
  v_mfma_f32_16x16x32_bf16 v[40:43], v[112:115], v[44:47], v[40:43]
  s_waitcnt vmcnt(4)
  buffer_load_dwordx4 v[136:139], v2, s[36:39], s41 offen offset:2048 nt
  v_and_b32_dpp v44, v37, v4 row_newbcast:9 row_mask:0xf bank_mask:0xf
  v_and_b32_dpp v45, v37, v5 row_newbcast:9 row_mask:0xf bank_mask:0xf
  v_and_b32_dpp v46, v37, v6 row_newbcast:9 row_mask:0xf bank_mask:0xf
  v_and_b32_dpp v47, v37, v7 row_newbcast:9 row_mask:0xf bank_mask:0xf
  v_mfma_f32_16x16x32_bf16 v[40:43], v[116:119], v[48:51], v[40:43]
  s_waitcnt vmcnt(4)
  buffer_load_dwordx4 v[140:143], v2, s[36:39], s41 offen offset:3072 nt
  v_and_b32_dpp v48, v37, v4 row_newbcast:13 row_mask:0xf bank_mask:0xf
  v_and_b32_dpp v49, v37, v5 row_newbcast:13 row_mask:0xf bank_mask:0xf
  v_and_b32_dpp v50, v37, v6 row_newbcast:13 row_mask:0xf bank_mask:0xf
  v_and_b32_dpp v51, v37, v7 row_newbcast:13 row_mask:0xf bank_mask:0xf
  v_mfma_f32_16x16x32_bf16 v[40:43], v[120:123], v[44:47], v[40:43]
  s_waitcnt vmcnt(4)
  s_add_u32 s41, s41, 0x4000
  buffer_load_dwordx4 v[144:147], v2, s[36:39], s41 offen offset:0 nt
  v_and_b32_dpp v44, v37, v4 row_newbcast:2 row_mask:0xf bank_mask:0xf
  v_and_b32_dpp v45, v37, v5 row_newbcast:2 row_mask:0xf bank_mask:0xf
  v_and_b32_dpp v46, v37, v6 row_newbcast:2 row_mask:0xf bank_mask:0xf
  v_and_b32_dpp v47, v37, v7 row_newbcast:2 row_mask:0xf bank_mask:0xf
  v_mfma_f32_16x16x32_bf16 v[40:43], v[124:127], v[48:51], v[40:43]
  s_waitcnt vmcnt(4)
  buffer_load_dwordx4 v[148:151], v2, s[36:39], s41 offen offset:1024 nt
  v_and_b32_dpp v48, v37, v4 row_newbcast:6 row_mask:0xf bank_mask:0xf
  v_and_b32_dpp v49, v37, v5 row_newbcast:6 row_mask:0xf bank_mask:0xf
  v_and_b32_dpp v50, v37, v6 row_newbcast:6 row_mask:0xf bank_mask:0xf
  v_and_b32_dpp v51, v37, v7 row_newbcast:6 row_mask:0xf bank_mask:0xf
  v_mfma_f32_16x16x32_bf16 v[40:43], v[128:131], v[44:47], v[40:43]
  s_waitcnt vmcnt(4)
  buffer_load_dwordx4 v[152:155], v2, s[36:39], s41 offen offset:2048 nt
  v_and_b32_dpp v44, v37, v4 row_newbcast:10 row_mask:0xf bank_mask:0xf
  v_and_b32_dpp v45, v37, v5 row_newbcast:10 row_mask:0xf bank_mask:0xf
  v_and_b32_dpp v46, v37, v6 row_newbcast:10 row_mask:0xf bank_mask:0xf
  v_and_b32_dpp v47, v37, v7 row_newbcast:10 row_mask:0xf bank_mask:0xf
  v_mfma_f32_16x16x32_bf16 v[40:43], v[132:135], v[48:51], v[40:43]
  s_waitcnt vmcnt(4)
  buffer_load_dwordx4 v[156:159], v2, s[36:39], s41 offen offset:3072 nt
  v_and_b32_dpp v48, v37, v4 row_newbcast:14 row_mask:0xf bank_mask:0xf
  v_and_b32_dpp v49, v37, v5 row_newbcast:14 row_mask:0xf bank_mask:0xf
  v_and_b32_dpp v50, v37, v6 row_newbcast:14 row_mask:0xf bank_mask:0xf
  v_and_b32_dpp v51, v37, v7 row_newbcast:14 row_mask:0xf bank_mask:0xf
  v_mfma_f32_16x16x32_bf16 v[40:43], v[136:139], v[44:47], v[40:43]
  s_waitcnt vmcnt(4)
  s_add_u32 s41, s41, 0x4000
  buffer_load_dwordx4 v[160:163], v2, s[36:39], s41 offen offset:0 nt
  v_and_b32_dpp v44, v37, v4 row_newbcast:3 row_mask:0xf bank_mask:0xf
  v_and_b32_dpp v45, v37, v5 row_newbcast:3 row_mask:0xf bank_mask:0xf
  v_and_b32_dpp v46, v37, v6 row_newbcast:3 row_mask:0xf bank_mask:0xf
  v_and_b32_dpp v47, v37, v7 row_newbcast:3 row_mask:0xf bank_mask:0xf
  v_mfma_f32_16x16x32_bf16 v[40:43], v[140:143], v[48:51], v[40:43]
  s_waitcnt vmcnt(4)
  buffer_load_dwordx4 v[164:167], v2, s[36:39], s41 offen offset:1024 nt
  v_and_b32_dpp v48, v37, v4 row_newbcast:7 row_mask:0xf bank_mask:0xf
  v_and_b32_dpp v49, v37, v5 row_newbcast:7 row_mask:0xf bank_mask:0xf
  v_and_b32_dpp v50, v37, v6 row_newbcast:7 row_mask:0xf bank_mask:0xf
  v_and_b32_dpp v51, v37, v7 row_newbcast:7 row_mask:0xf bank_mask:0xf
  v_mfma_f32_16x16x32_bf16 v[40:43], v[144:147], v[44:47], v[40:43]
  s_waitcnt vmcnt(4)
  buffer_load_dwordx4 v[168:171], v2, s[36:39], s41 offen offset:2048 nt
  v_and_b32_dpp v44, v37, v4 row_newbcast:11 row_mask:0xf bank_mask:0xf
  v_and_b32_dpp v45, v37, v5 row_newbcast:11 row_mask:0xf bank_mask:0xf
  v_and_b32_dpp v46, v37, v6 row_newbcast:11 row_mask:0xf bank_mask:0xf
  v_and_b32_dpp v47, v37, v7 row_newbcast:11 row_mask:0xf bank_mask:0xf
  v_mfma_f32_16x16x32_bf16 v[40:43], v[148:151], v[48:51], v[40:43]
  s_waitcnt vmcnt(4)
  buffer_load_dwordx4 v[172:175], v2, s[36:39], s41 offen offset:3072 nt
  v_and_b32_dpp v48, v37, v4 row_newbcast:15 row_mask:0xf bank_mask:0xf
  v_and_b32_dpp v49, v37, v5 row_newbcast:15 row_mask:0xf bank_mask:0xf
  v_and_b32_dpp v50, v37, v6 row_newbcast:15 row_mask:0xf bank_mask:0xf
  v_and_b32_dpp v51, v37, v7 row_newbcast:15 row_mask:0xf bank_mask:0xf
  v_mfma_f32_16x16x32_bf16 v[40:43], v[152:155], v[44:47], v[40:43]
  s_waitcnt vmcnt(4)
  s_add_u32 s41, s41, 0x4000
  buffer_load_dwordx4 v[176:179], v2, s[36:39], s41 offen offset:0 nt
  v_and_b32_dpp v44, v38, v4 row_newbcast:0 row_mask:0xf bank_mask:0xf
  v_and_b32_dpp v45, v38, v5 row_newbcast:0 row_mask:0xf bank_mask:0xf
  v_and_b32_dpp v46, v38, v6 row_newbcast:0 row_mask:0xf bank_mask:0xf
  v_and_b32_dpp v47, v38, v7 row_newbcast:0 row_mask:0xf bank_mask:0xf
  v_mfma_f32_16x16x32_bf16 v[40:43], v[156:159], v[48:51], v[40:43]
  s_waitcnt vmcnt(4)
  buffer_load_dwordx4 v[180:183], v2, s[36:39], s41 offen offset:1024 nt
  v_and_b32_dpp v48, v38, v4 row_newbcast:4 row_mask:0xf bank_mask:0xf
  v_and_b32_dpp v49, v38, v5 row_newbcast:4 row_mask:0xf bank_mask:0xf
  v_and_b32_dpp v50, v38, v6 row_newbcast:4 row_mask:0xf bank_mask:0xf
  v_and_b32_dpp v51, v38, v7 row_newbcast:4 row_mask:0xf bank_mask:0xf
  v_mfma_f32_16x16x32_bf16 v[40:43], v[160:163], v[44:47], v[40:43]
  s_waitcnt vmcnt(4)
  buffer_load_dwordx4 v[184:187], v2, s[36:39], s41 offen offset:2048 nt
  v_and_b32_dpp v44, v38, v4 row_newbcast:8 row_mask:0xf bank_mask:0xf
  v_and_b32_dpp v45, v38, v5 row_newbcast:8 row_mask:0xf bank_mask:0xf
  v_and_b32_dpp v46, v38, v6 row_newbcast:8 row_mask:0xf bank_mask:0xf
  v_and_b32_dpp v47, v38, v7 row_newbcast:8 row_mask:0xf bank_mask:0xf
  v_mfma_f32_16x16x32_bf16 v[40:43], v[164:167], v[48:51], v[40:43]
  s_waitcnt vmcnt(4)
  buffer_load_dwordx4 v[188:191], v2, s[36:39], s41 offen offset:3072 nt
  v_and_b32_dpp v48, v38, v4 row_newbcast:12 row_mask:0xf bank_mask:0xf
  v_and_b32_dpp v49, v38, v5 row_newbcast:12 row_mask:0xf bank_mask:0xf
  v_and_b32_dpp v50, v38, v6 row_newbcast:12 row_mask:0xf bank_mask:0xf
  v_and_b32_dpp v51, v38, v7 row_newbcast:12 row_mask:0xf bank_mask:0xf
  v_mfma_f32_16x16x32_bf16 v[40:43], v[168:171], v[44:47], v[40:43]
  s_waitcnt vmcnt(4)
  s_add_u32 s41, s41, 0x4000
  buffer_load_dwordx4 v[192:195], v2, s[36:39], s41 offen offset:0 nt
  v_and_b32_dpp v44, v38, v4 row_newbcast:1 row_mask:0xf bank_mask:0xf
  v_and_b32_dpp v45, v38, v5 row_newbcast:1 row_mask:0xf bank_mask:0xf
  v_and_b32_dpp v46, v38, v6 row_newbcast:1 row_mask:0xf bank_mask:0xf
  v_and_b32_dpp v47, v38, v7 row_newbcast:1 row_mask:0xf bank_mask:0xf
  v_mfma_f32_16x16x32_bf16 v[40:43], v[172:175], v[48:51], v[40:43]
  s_waitcnt vmcnt(4)
  buffer_load_dwordx4 v[196:199], v2, s[36:39], s41 offen offset:1024 nt
  v_and_b32_dpp v48, v38, v4 row_newbcast:5 row_mask:0xf bank_mask:0xf
  v_and_b32_dpp v49, v38, v5 row_newbcast:5 row_mask:0xf bank_mask:0xf
  v_and_b32_dpp v50, v38, v6 row_newbcast:5 row_mask:0xf bank_mask:0xf
  v_and_b32_dpp v51, v38, v7 row_newbcast:5 row_mask:0xf bank_mask:0xf
  v_mfma_f32_16x16x32_bf16 v[40:43], v[176:179], v[44:47], v[40:43]
  s_waitcnt vmcnt(4)
  buffer_load_dwordx4 v[200:203], v2, s[36:39], s41 offen offset:2048 nt
  v_and_b32_dpp v44, v38, v4 row_newbcast:9 row_mask:0xf bank_mask:0xf
  v_and_b32_dpp v45, v38, v5 row_newbcast:9 row_mask:0xf bank_mask:0xf
  v_and_b32_dpp v46, v38, v6 row_newbcast:9 row_mask:0xf bank_mask:0xf
  v_and_b32_dpp v47, v38, v7 row_newbcast:9 row_mask:0xf bank_mask:0xf
  v_mfma_f32_16x16x32_bf16 v[40:43], v[180:183], v[48:51], v[40:43]
  s_waitcnt vmcnt(4)
  buffer_load_dwordx4 v[204:207], v2, s[36:39], s41 offen offset:3072 nt
  v_and_b32_dpp v48, v38, v4 row_newbcast:13 row_mask:0xf bank_mask:0xf
  v_and_b32_dpp v49, v38, v5 row_newbcast:13 row_mask:0xf bank_mask:0xf
  v_and_b32_dpp v50, v38, v6 row_newbcast:13 row_mask:0xf bank_mask:0xf
  v_and_b32_dpp v51, v38, v7 row_newbcast:13 row_mask:0xf bank_mask:0xf
  v_mfma_f32_16x16x32_bf16 v[40:43], v[184:187], v[44:47], v[40:43]
  s_waitcnt vmcnt(4)
  s_add_u32 s41, s41, 0x4000
  buffer_load_dwordx4 v[208:211], v2, s[36:39], s41 offen offset:0 nt
  v_and_b32_dpp v44, v38, v4 row_newbcast:2 row_mask:0xf bank_mask:0xf
  v_and_b32_dpp v45, v38, v5 row_newbcast:2 row_mask:0xf bank_mask:0xf
  v_and_b32_dpp v46, v38, v6 row_newbcast:2 row_mask:0xf bank_mask:0xf
  v_and_b32_dpp v47, v38, v7 row_newbcast:2 row_mask:0xf bank_mask:0xf
  v_mfma_f32_16x16x32_bf16 v[40:43], v[188:191], v[48:51], v[40:43]
  s_waitcnt vmcnt(4)
  buffer_load_dwordx4 v[212:215], v2, s[36:39], s41 offen offset:1024 nt
  v_and_b32_dpp v48, v38, v4 row_newbcast:6 row_mask:0xf bank_mask:0xf
  v_and_b32_dpp v49, v38, v5 row_newbcast:6 row_mask:0xf bank_mask:0xf
  v_and_b32_dpp v50, v38, v6 row_newbcast:6 row_mask:0xf bank_mask:0xf
  v_and_b32_dpp v51, v38, v7 row_newbcast:6 row_mask:0xf bank_mask:0xf
  v_mfma_f32_16x16x32_bf16 v[40:43], v[192:195], v[44:47], v[40:43]
  s_waitcnt vmcnt(4)
  buffer_load_dwordx4 v[216:219], v2, s[36:39], s41 offen offset:2048 nt
  v_and_b32_dpp v44, v38, v4 row_newbcast:10 row_mask:0xf bank_mask:0xf
  v_and_b32_dpp v45, v38, v5 row_newbcast:10 row_mask:0xf bank_mask:0xf
  v_and_b32_dpp v46, v38, v6 row_newbcast:10 row_mask:0xf bank_mask:0xf
  v_and_b32_dpp v47, v38, v7 row_newbcast:10 row_mask:0xf bank_mask:0xf
  v_mfma_f32_16x16x32_bf16 v[40:43], v[196:199], v[48:51], v[40:43]
  s_waitcnt vmcnt(4)
  buffer_load_dwordx4 v[220:223], v2, s[36:39], s41 offen offset:3072 nt
  v_and_b32_dpp v48, v38, v4 row_newbcast:14 row_mask:0xf bank_mask:0xf
  v_and_b32_dpp v49, v38, v5 row_newbcast:14 row_mask:0xf bank_mask:0xf
  v_and_b32_dpp v50, v38, v6 row_newbcast:14 row_mask:0xf bank_mask:0xf
  v_and_b32_dpp v51, v38, v7 row_newbcast:14 row_mask:0xf bank_mask:0xf
  v_mfma_f32_16x16x32_bf16 v[40:43], v[200:203], v[44:47], v[40:43]
  s_waitcnt vmcnt(4)
  s_add_u32 s41, s41, 0x4000
  buffer_load_dwordx4 v[64:67], v2, s[36:39], s41 offen offset:0 nt
  v_and_b32_dpp v44, v38, v4 row_newbcast:3 row_mask:0xf bank_mask:0xf
  v_and_b32_dpp v45, v38, v5 row_newbcast:3 row_mask:0xf bank_mask:0xf
  v_and_b32_dpp v46, v38, v6 row_newbcast:3 row_mask:0xf bank_mask:0xf
  v_and_b32_dpp v47, v38, v7 row_newbcast:3 row_mask:0xf bank_mask:0xf
  v_mfma_f32_16x16x32_bf16 v[40:43], v[204:207], v[48:51], v[40:43]
  s_waitcnt vmcnt(4)
  buffer_load_dwordx4 v[68:71], v2, s[36:39], s41 offen offset:1024 nt
  v_and_b32_dpp v48, v38, v4 row_newbcast:7 row_mask:0xf bank_mask:0xf
  v_and_b32_dpp v49, v38, v5 row_newbcast:7 row_mask:0xf bank_mask:0xf
  v_and_b32_dpp v50, v38, v6 row_newbcast:7 row_mask:0xf bank_mask:0xf
  v_and_b32_dpp v51, v38, v7 row_newbcast:7 row_mask:0xf bank_mask:0xf
  v_mfma_f32_16x16x32_bf16 v[40:43], v[208:211], v[44:47], v[40:43]
  s_waitcnt vmcnt(4)
  buffer_load_dwordx4 v[72:75], v2, s[36:39], s41 offen offset:2048 nt
  v_and_b32_dpp v44, v38, v4 row_newbcast:11 row_mask:0xf bank_mask:0xf
  v_and_b32_dpp v45, v38, v5 row_newbcast:11 row_mask:0xf bank_mask:0xf
  v_and_b32_dpp v46, v38, v6 row_newbcast:11 row_mask:0xf bank_mask:0xf
  v_and_b32_dpp v47, v38, v7 row_newbcast:11 row_mask:0xf bank_mask:0xf
  v_mfma_f32_16x16x32_bf16 v[40:43], v[212:215], v[48:51], v[40:43]
  s_waitcnt vmcnt(4)
  buffer_load_dwordx4 v[76:79], v2, s[36:39], s41 offen offset:3072 nt
  v_and_b32_dpp v48, v38, v4 row_newbcast:15 row_mask:0xf bank_mask:0xf
  v_and_b32_dpp v49, v38, v5 row_newbcast:15 row_mask:0xf bank_mask:0xf
  v_and_b32_dpp v50, v38, v6 row_newbcast:15 row_mask:0xf bank_mask:0xf
  v_and_b32_dpp v51, v38, v7 row_newbcast:15 row_mask:0xf bank_mask:0xf
  v_mfma_f32_16x16x32_bf16 v[40:43], v[216:219], v[44:47], v[40:43]
  s_waitcnt vmcnt(4)
  s_add_u32 s41, s41, 0x4000
  buffer_load_dwordx4 v[80:83], v2, s[36:39], s41 offen offset:0 nt
  v_and_b32_dpp v44, v39, v4 row_newbcast:0 row_mask:0xf bank_mask:0xf
  v_and_b32_dpp v45, v39, v5 row_newbcast:0 row_mask:0xf bank_mask:0xf
  v_and_b32_dpp v46, v39, v6 row_newbcast:0 row_mask:0xf bank_mask:0xf
  v_and_b32_dpp v47, v39, v7 row_newbcast:0 row_mask:0xf bank_mask:0xf
  v_mfma_f32_16x16x32_bf16 v[40:43], v[220:223], v[48:51], v[40:43]
  s_waitcnt vmcnt(4)
  buffer_load_dwordx4 v[84:87], v2, s[36:39], s41 offen offset:1024 nt
  s_lshl_b32 s60, s3, 2
  v_mov_b32 v52, s60
  ds_read_b32 v53, v52 offset:13376
  v_and_b32_dpp v48, v39, v4 row_newbcast:4 row_mask:0xf bank_mask:0xf
  v_and_b32_dpp v49, v39, v5 row_newbcast:4 row_mask:0xf bank_mask:0xf
  v_and_b32_dpp v50, v39, v6 row_newbcast:4 row_mask:0xf bank_mask:0xf
  v_and_b32_dpp v51, v39, v7 row_newbcast:4 row_mask:0xf bank_mask:0xf
  v_mfma_f32_16x16x32_bf16 v[40:43], v[64:67], v[44:47], v[40:43]
  s_waitcnt vmcnt(4)
  buffer_load_dwordx4 v[88:91], v2, s[36:39], s41 offen offset:2048 nt
  v_and_b32_dpp v44, v39, v4 row_newbcast:8 row_mask:0xf bank_mask:0xf
  v_and_b32_dpp v45, v39, v5 row_newbcast:8 row_mask:0xf bank_mask:0xf
  v_and_b32_dpp v46, v39, v6 row_newbcast:8 row_mask:0xf bank_mask:0xf
  v_and_b32_dpp v47, v39, v7 row_newbcast:8 row_mask:0xf bank_mask:0xf
  v_mfma_f32_16x16x32_bf16 v[40:43], v[68:71], v[48:51], v[40:43]
  s_waitcnt vmcnt(4)
  buffer_load_dwordx4 v[92:95], v2, s[36:39], s41 offen offset:3072 nt
  v_and_b32_dpp v48, v39, v4 row_newbcast:12 row_mask:0xf bank_mask:0xf
  v_and_b32_dpp v49, v39, v5 row_newbcast:12 row_mask:0xf bank_mask:0xf
  v_and_b32_dpp v50, v39, v6 row_newbcast:12 row_mask:0xf bank_mask:0xf
  v_and_b32_dpp v51, v39, v7 row_newbcast:12 row_mask:0xf bank_mask:0xf
  v_mfma_f32_16x16x32_bf16 v[40:43], v[72:75], v[44:47], v[40:43]
  s_waitcnt vmcnt(4)
  s_add_u32 s41, s41, 0x4000
  buffer_load_dwordx4 v[96:99], v2, s[36:39], s41 offen offset:0 nt
  v_and_b32_dpp v44, v39, v4 row_newbcast:1 row_mask:0xf bank_mask:0xf
  v_and_b32_dpp v45, v39, v5 row_newbcast:1 row_mask:0xf bank_mask:0xf
  v_and_b32_dpp v46, v39, v6 row_newbcast:1 row_mask:0xf bank_mask:0xf
  v_and_b32_dpp v47, v39, v7 row_newbcast:1 row_mask:0xf bank_mask:0xf
  v_mfma_f32_16x16x32_bf16 v[40:43], v[76:79], v[48:51], v[40:43]
  s_waitcnt vmcnt(4)
  buffer_load_dwordx4 v[100:103], v2, s[36:39], s41 offen offset:1024 nt
  v_and_b32 v54, 3, v0
  v_lshlrev_b32 v54, 5, v54
  v_lshrrev_b32 v55, 4, v0
  v_lshlrev_b32 v55, 3, v55
  v_add_u32 v54, v54, v55
  s_lshl_b32 s60, s65, 1
  s_add_u32 s60, s60, s66
  v_bfe_u32 v56, v0, 2, 1
  v_subrev_u32 v56, s60, v56
  v_add_u32 v60, 0, v56
  v_and_b32 v60, 7, v60
  v_add_u32 v60, v60, v54
  v_lshlrev_b32 v60, 2, v60
  s_lshl_b32 s60, s3, 9
  v_add_u32 v60, s60, v60
  v_add_u32 v61, 2, v56
  v_and_b32 v61, 7, v61
  v_add_u32 v61, v61, v54
  v_lshlrev_b32 v61, 2, v61
  s_lshl_b32 s60, s3, 9
  v_add_u32 v61, s60, v61
  v_add_u32 v62, 4, v56
  v_and_b32 v62, 7, v62
  v_add_u32 v62, v62, v54
  v_lshlrev_b32 v62, 2, v62
  s_lshl_b32 s60, s3, 9
  v_add_u32 v62, s60, v62
  v_add_u32 v63, 6, v56
  v_and_b32 v63, 7, v63
  v_add_u32 v63, v63, v54
  v_lshlrev_b32 v63, 2, v63
  s_lshl_b32 s60, s3, 9
  v_add_u32 v63, s60, v63
  v_and_b32_dpp v48, v39, v4 row_newbcast:5 row_mask:0xf bank_mask:0xf
  v_and_b32_dpp v49, v39, v5 row_newbcast:5 row_mask:0xf bank_mask:0xf
  v_and_b32_dpp v50, v39, v6 row_newbcast:5 row_mask:0xf bank_mask:0xf
  v_and_b32_dpp v51, v39, v7 row_newbcast:5 row_mask:0xf bank_mask:0xf
  v_mfma_f32_16x16x32_bf16 v[40:43], v[80:83], v[44:47], v[40:43]
  s_waitcnt vmcnt(4)
  buffer_load_dwordx4 v[104:107], v2, s[36:39], s41 offen offset:2048 nt
  v_and_b32_dpp v44, v39, v4 row_newbcast:9 row_mask:0xf bank_mask:0xf
  v_and_b32_dpp v45, v39, v5 row_newbcast:9 row_mask:0xf bank_mask:0xf
  v_and_b32_dpp v46, v39, v6 row_newbcast:9 row_mask:0xf bank_mask:0xf
  v_and_b32_dpp v47, v39, v7 row_newbcast:9 row_mask:0xf bank_mask:0xf
  v_mfma_f32_16x16x32_bf16 v[40:43], v[84:87], v[48:51], v[40:43]
  s_waitcnt vmcnt(4)
  buffer_load_dwordx4 v[108:111], v2, s[36:39], s41 offen offset:3072 nt
  v_and_b32_dpp v48, v39, v4 row_newbcast:13 row_mask:0xf bank_mask:0xf
  v_and_b32_dpp v49, v39, v5 row_newbcast:13 row_mask:0xf bank_mask:0xf
  v_and_b32_dpp v50, v39, v6 row_newbcast:13 row_mask:0xf bank_mask:0xf
  v_and_b32_dpp v51, v39, v7 row_newbcast:13 row_mask:0xf bank_mask:0xf
  v_mfma_f32_16x16x32_bf16 v[40:43], v[88:91], v[44:47], v[40:43]
  s_waitcnt vmcnt(4)
  s_add_u32 s41, s41, 0x4000
  buffer_load_dwordx4 v[112:115], v2, s[36:39], s41 offen offset:0 nt
  v_and_b32_dpp v44, v39, v4 row_newbcast:2 row_mask:0xf bank_mask:0xf
  v_and_b32_dpp v45, v39, v5 row_newbcast:2 row_mask:0xf bank_mask:0xf
  v_and_b32_dpp v46, v39, v6 row_newbcast:2 row_mask:0xf bank_mask:0xf
  v_and_b32_dpp v47, v39, v7 row_newbcast:2 row_mask:0xf bank_mask:0xf
  v_mfma_f32_16x16x32_bf16 v[40:43], v[92:95], v[48:51], v[40:43]
  s_waitcnt vmcnt(4)
  buffer_load_dwordx4 v[116:119], v2, s[36:39], s41 offen offset:1024 nt
  v_and_b32_dpp v48, v39, v4 row_newbcast:6 row_mask:0xf bank_mask:0xf
  v_and_b32_dpp v49, v39, v5 row_newbcast:6 row_mask:0xf bank_mask:0xf
  v_and_b32_dpp v50, v39, v6 row_newbcast:6 row_mask:0xf bank_mask:0xf
  v_and_b32_dpp v51, v39, v7 row_newbcast:6 row_mask:0xf bank_mask:0xf
  v_mfma_f32_16x16x32_bf16 v[40:43], v[96:99], v[44:47], v[40:43]
  s_waitcnt vmcnt(4)
  buffer_load_dwordx4 v[120:123], v2, s[36:39], s41 offen offset:2048 nt
  v_and_b32_dpp v44, v39, v4 row_newbcast:10 row_mask:0xf bank_mask:0xf
  v_and_b32_dpp v45, v39, v5 row_newbcast:10 row_mask:0xf bank_mask:0xf
  v_and_b32_dpp v46, v39, v6 row_newbcast:10 row_mask:0xf bank_mask:0xf
  v_and_b32_dpp v47, v39, v7 row_newbcast:10 row_mask:0xf bank_mask:0xf
  v_mfma_f32_16x16x32_bf16 v[40:43], v[100:103], v[48:51], v[40:43]
  s_waitcnt vmcnt(4)
  buffer_load_dwordx4 v[124:127], v2, s[36:39], s41 offen offset:3072 nt
  v_and_b32_dpp v48, v39, v4 row_newbcast:14 row_mask:0xf bank_mask:0xf
  v_and_b32_dpp v49, v39, v5 row_newbcast:14 row_mask:0xf bank_mask:0xf
  v_and_b32_dpp v50, v39, v6 row_newbcast:14 row_mask:0xf bank_mask:0xf
  v_and_b32_dpp v51, v39, v7 row_newbcast:14 row_mask:0xf bank_mask:0xf
  v_mfma_f32_16x16x32_bf16 v[40:43], v[104:107], v[44:47], v[40:43]
  v_and_b32_dpp v44, v39, v4 row_newbcast:3 row_mask:0xf bank_mask:0xf
  v_and_b32_dpp v45, v39, v5 row_newbcast:3 row_mask:0xf bank_mask:0xf
  v_and_b32_dpp v46, v39, v6 row_newbcast:3 row_mask:0xf bank_mask:0xf
  v_and_b32_dpp v47, v39, v7 row_newbcast:3 row_mask:0xf bank_mask:0xf
  s_waitcnt vmcnt(4)
  v_mfma_f32_16x16x32_bf16 v[40:43], v[108:111], v[48:51], v[40:43]
  v_and_b32_dpp v48, v39, v4 row_newbcast:7 row_mask:0xf bank_mask:0xf
  v_and_b32_dpp v49, v39, v5 row_newbcast:7 row_mask:0xf bank_mask:0xf
  v_and_b32_dpp v50, v39, v6 row_newbcast:7 row_mask:0xf bank_mask:0xf
  v_and_b32_dpp v51, v39, v7 row_newbcast:7 row_mask:0xf bank_mask:0xf
  s_waitcnt vmcnt(3)
  v_mfma_f32_16x16x32_bf16 v[40:43], v[112:115], v[44:47], v[40:43]
  v_and_b32_dpp v44, v39, v4 row_newbcast:11 row_mask:0xf bank_mask:0xf
  v_and_b32_dpp v45, v39, v5 row_newbcast:11 row_mask:0xf bank_mask:0xf
  v_and_b32_dpp v46, v39, v6 row_newbcast:11 row_mask:0xf bank_mask:0xf
  v_and_b32_dpp v47, v39, v7 row_newbcast:11 row_mask:0xf bank_mask:0xf
  s_waitcnt vmcnt(2)
  v_mfma_f32_16x16x32_bf16 v[40:43], v[116:119], v[48:51], v[40:43]
  v_and_b32_dpp v48, v39, v4 row_newbcast:15 row_mask:0xf bank_mask:0xf
  v_and_b32_dpp v49, v39, v5 row_newbcast:15 row_mask:0xf bank_mask:0xf
  v_and_b32_dpp v50, v39, v6 row_newbcast:15 row_mask:0xf bank_mask:0xf
  v_and_b32_dpp v51, v39, v7 row_newbcast:15 row_mask:0xf bank_mask:0xf
  s_waitcnt vmcnt(1)
  v_mfma_f32_16x16x32_bf16 v[40:43], v[120:123], v[44:47], v[40:43]
  s_waitcnt vmcnt(0)
  v_mfma_f32_16x16x32_bf16 v[40:43], v[124:127], v[48:51], v[40:43]
  s_waitcnt lgkmcnt(0)
  v_cmp_ne_u32 vcc, -1, v53
  s_nop 4
  s_cbranch_vccnz L_wfd_76
  s_mov_b32 s61, 0x400000
L_wf_75:
  ds_read_b32 v53, v52 offset:13376
  s_waitcnt lgkmcnt(0)
  v_cmp_ne_u32 vcc, -1, v53
  s_nop 3
  s_cbranch_vccnz L_wfd_76
  s_sleep 1
  s_sub_u32 s61, s61, 1
  s_cmp_lg_u32 s61, 0
  s_cbranch_scc1 L_wf_75
L_wfd_76:
  v_mul_f32 v40, v40, v53
  v_mul_f32 v41, v41, v53
  v_mul_f32 v42, v42, v53
  v_mul_f32 v43, v43, v53
  s_mov_b32 exec_lo, 0x00ff00ff
  s_mov_b32 exec_hi, 0x00ff00ff
  ds_write_b32 v60, v40 offset:14080
  ds_write_b32 v61, v41 offset:14080
  ds_write_b32 v62, v42 offset:14080
  ds_write_b32 v63, v43 offset:14080
  s_mov_b64 exec, -1
  s_waitcnt lgkmcnt(0)
  s_barrier
  s_endpgm
L_helper:
  s_sub_u32 s63, s3, 4
  s_mov_b32 s59, 0
  s_add_u32 s4, s30, 0x148000
  s_addc_u32 s5, s31, 0
  s_load_dword s58, s[4:5], 0
  s_mov_b32 s32, s14
  s_and_b32 s33, s15, 0xffff
  s_mov_b32 s34, 0x500000
  s_mov_b32 s35, 0x20000
  s_mov_b32 s40, s8
  s_and_b32 s41, s9, 0xffff
  s_mov_b32 s42, 0x1400
  s_mov_b32 s43, 0x20000
  s_mov_b32 s44, s30
  s_and_b32 s45, s31, 0xffff
  s_mov_b32 s46, 0x460000
  s_mov_b32 s47, 0x20000
  s_mul_i32 s60, s63, 1280
  v_lshlrev_b32 v1, 2, v0
  buffer_load_dword v16, v1, s[40:43], s60 offen offset:0
  buffer_load_dword v17, v1, s[40:43], s60 offen offset:256
  buffer_load_dword v18, v1, s[40:43], s60 offen offset:512
  buffer_load_dword v19, v1, s[40:43], s60 offen offset:768
  buffer_load_dword v20, v1, s[40:43], s60 offen offset:1024
  v_lshrrev_b32 v2, 4, v0
  v_lshlrev_b32 v2, 13, v2
  v_and_b32 v3, 15, v0
  v_lshlrev_b32 v3, 4, v3
  v_add_u32 v2, v2, v3
  s_lshl_b32 s57, s65, 1
  s_add_u32 s57, s57, s66
  s_mul_i32 s56, s57, 80
  s_mul_i32 s60, s63, 20
  s_add_u32 s56, s56, s60
  s_lshl_b32 s60, s56, 13
  s_lshl_b32 s61, s64, 8
  s_add_u32 s60, s60, s61
  buffer_load_dwordx4 v[96:99], v2, s[32:35], s60 offen nt
  s_add_u32 s60, s60, 0x8000
  buffer_load_dwordx4 v[100:103], v2, s[32:35], s60 offen nt
  s_add_u32 s60, s60, 0x8000
  buffer_load_dwordx4 v[104:107], v2, s[32:35], s60 offen nt
  s_add_u32 s60, s60, 0x8000
  buffer_load_dwordx4 v[108:111], v2, s[32:35], s60 offen nt
  s_add_u32 s60, s60, 0x8000
  buffer_load_dwordx4 v[112:115], v2, s[32:35], s60 offen nt
  s_barrier
  s_mov_b32 s36, s16
  s_and_b32 s37, s17, 0xffff
  s_mov_b32 s38, 0x500000
  s_mov_b32 s39, 0x20000
  v_and_b32 v9, 15, v0
  v_and_b32 v10, 7, v9
  v_and_b32 v11, 1, v10
  v_cmp_eq_u32 vcc, 1, v11
  v_mov_b32 v11, 0xffff
  v_mov_b32 v4, 0xffff0000
  v_cndmask_b32 v11, v11, v4, vcc
  v_lshrrev_b32 v10, 1, v10
  v_cmp_eq_u32 vcc, 0, v10
  s_nop 1
  v_cndmask_b32 v4, 0, v11, vcc
  v_cmp_eq_u32 vcc, 1, v10
  s_nop 1
  v_cndmask_b32 v5, 0, v11, vcc
  v_cmp_eq_u32 vcc, 2, v10
  s_nop 1
  v_cndmask_b32 v6, 0, v11, vcc
  v_cmp_eq_u32 vcc, 3, v10
  s_nop 1
  v_cndmask_b32 v7, 0, v11, vcc
  s_waitcnt vmcnt(5) lgkmcnt(0)
  s_add_u32 s58, s58, 1
  v_lshlrev_b32 v32, 16, v16
  v_and_b32 v33, 0xffff0000, v16
  v_lshlrev_b32 v34, 16, v17
  v_and_b32 v35, 0xffff0000, v17
  v_lshlrev_b32 v36, 16, v18
  v_and_b32 v37, 0xffff0000, v18
  v_lshlrev_b32 v38, 16, v19
  v_and_b32 v39, 0xffff0000, v19
  v_lshlrev_b32 v40, 16, v20
  v_and_b32 v41, 0xffff0000, v20
  v_add_f32 v42, v32, v33
  v_add_f32 v43, v34, v35
  v_add_f32 v42, v42, v36
  v_add_f32 v43, v43, v37
  v_add_f32 v42, v42, v38
  v_add_f32 v43, v43, v39
  v_add_f32 v42, v42, v40
  v_add_f32 v43, v43, v41
  v_add_f32 v42, v42, v43
  s_nop 1
  v_add_f32_dpp v42, v42, v42 quad_perm:[1,0,3,2] row_mask:0xf bank_mask:0xf
  s_nop 1
  v_add_f32_dpp v42, v42, v42 quad_perm:[2,3,0,1] row_mask:0xf bank_mask:0xf
  s_nop 1
  v_add_f32_dpp v42, v42, v42 row_half_mirror row_mask:0xf bank_mask:0xf
  s_nop 1
  v_add_f32_dpp v42, v42, v42 row_mirror row_mask:0xf bank_mask:0xf
  v_mov_b32 v43, v42
  s_nop 1
  v_permlane16_swap_b32 v42, v43
  v_add_f32 v42, v42, v43
  v_mov_b32 v43, v42
  s_nop 1
  v_permlane32_swap_b32 v42, v43
  v_add_f32 v42, v42, v43
  v_mul_f32 v42, 0x3acccccd, v42
  v_sub_f32 v45, v32, v42
  v_mul_f32 v44, v45, v45
  v_sub_f32 v45, v33, v42
  v_fmac_f32 v44, v45, v45
  v_sub_f32 v45, v34, v42
  v_fmac_f32 v44, v45, v45
  v_sub_f32 v45, v35, v42
  v_fmac_f32 v44, v45, v45
  v_sub_f32 v45, v36, v42
  v_fmac_f32 v44, v45, v45
  v_sub_f32 v45, v37, v42
  v_fmac_f32 v44, v45, v45
  v_sub_f32 v45, v38, v42
  v_fmac_f32 v44, v45, v45
  v_sub_f32 v45, v39, v42
  v_fmac_f32 v44, v45, v45
  v_sub_f32 v45, v40, v42
  v_fmac_f32 v44, v45, v45
  v_sub_f32 v45, v41, v42
  v_fmac_f32 v44, v45, v45
  s_nop 1
  v_add_f32_dpp v44, v44, v44 quad_perm:[1,0,3,2] row_mask:0xf bank_mask:0xf
  s_nop 1
  v_add_f32_dpp v44, v44, v44 quad_perm:[2,3,0,1] row_mask:0xf bank_mask:0xf
  s_nop 1
  v_add_f32_dpp v44, v44, v44 row_half_mirror row_mask:0xf bank_mask:0xf
  s_nop 1
  v_add_f32_dpp v44, v44, v44 row_mirror row_mask:0xf bank_mask:0xf
  v_mov_b32 v43, v44
  s_nop 1
  v_permlane16_swap_b32 v44, v43
  v_add_f32 v44, v44, v43
  v_mov_b32 v43, v44
  s_nop 1
  v_permlane32_swap_b32 v44, v43
  v_add_f32 v44, v44, v43
  v_mul_f32 v44, 0x3acccccd, v44
  v_cvt_pk_bf16_f32 v44, v44, v44
  v_lshlrev_b32 v44, 16, v44
  v_add_f32 v44, 0x3727c5ac, v44
  v_cvt_pk_bf16_f32 v44, v44, v44
  v_lshlrev_b32 v44, 16, v44
  v_sqrt_f32 v44, v44
  s_nop 0
  v_cvt_pk_bf16_f32 v44, v44, v44
  v_lshlrev_b32 v44, 16, v44
  v_cvt_pk_bf16_f32 v42, v42, v42
  v_lshlrev_b32 v42, 16, v42
  v_rcp_f32 v43, v44
  v_sub_f32 v32, v32, v42
  v_sub_f32 v33, v33, v42
  v_sub_f32 v34, v34, v42
  v_sub_f32 v35, v35, v42
  v_sub_f32 v36, v36, v42
  v_sub_f32 v37, v37, v42
  v_sub_f32 v38, v38, v42
  v_sub_f32 v39, v39, v42
  v_sub_f32 v40, v40, v42
  v_sub_f32 v41, v41, v42
  v_cvt_pk_bf16_f32 v24, v32, v33
  v_cvt_pk_bf16_f32 v25, v34, v35
  v_cvt_pk_bf16_f32 v26, v36, v37
  v_cvt_pk_bf16_f32 v27, v38, v39
  v_cvt_pk_bf16_f32 v28, v40, v41
  v_lshlrev_b32 v32, 16, v24
  v_and_b32 v33, 0xffff0000, v24
  v_lshlrev_b32 v34, 16, v25
  v_and_b32 v35, 0xffff0000, v25
  v_lshlrev_b32 v36, 16, v26
  v_and_b32 v37, 0xffff0000, v26
  v_lshlrev_b32 v38, 16, v27
  v_and_b32 v39, 0xffff0000, v27
  v_lshlrev_b32 v40, 16, v28
  v_and_b32 v41, 0xffff0000, v28
  v_mul_f32 v45, v32, v43
  v_fma_f32 v32, -v45, v44, v32
  v_fma_f32 v32, v32, v43, v45
  v_mul_f32 v45, v33, v43
  v_fma_f32 v33, -v45, v44, v33
  v_fma_f32 v33, v33, v43, v45
  v_mul_f32 v45, v34, v43
  v_fma_f32 v34, -v45, v44, v34
  v_fma_f32 v34, v34, v43, v45
  v_mul_f32 v45, v35, v43
  v_fma_f32 v35, -v45, v44, v35
  v_fma_f32 v35, v35, v43, v45
  v_mul_f32 v45, v36, v43
  v_fma_f32 v36, -v45, v44, v36
  v_fma_f32 v36, v36, v43, v45
  v_mul_f32 v45, v37, v43
  v_fma_f32 v37, -v45, v44, v37
  v_fma_f32 v37, v37, v43, v45
  v_mul_f32 v45, v38, v43
  v_fma_f32 v38, -v45, v44, v38
  v_fma_f32 v38, v38, v43, v45
  v_mul_f32 v45, v39, v43
  v_fma_f32 v39, -v45, v44, v39
  v_fma_f32 v39, v39, v43, v45
  v_mul_f32 v45, v40, v43
  v_fma_f32 v40, -v45, v44, v40
  v_fma_f32 v40, v40, v43, v45
  v_mul_f32 v45, v41, v43
  v_fma_f32 v41, -v45, v44, v41
  v_fma_f32 v41, v41, v43, v45
  v_cvt_pk_bf16_f32 v24, v32, v33
  v_cvt_pk_bf16_f32 v25, v34, v35
  v_cvt_pk_bf16_f32 v26, v36, v37
  v_cvt_pk_bf16_f32 v27, v38, v39
  v_cvt_pk_bf16_f32 v28, v40, v41
  s_mul_i32 s60, s63, 1280
  v_add_u32 v9, s60, v1
  ds_write_b32 v9, v24 offset:8192
  ds_write_b32 v9, v25 offset:8448
  ds_write_b32 v9, v26 offset:8704
  ds_write_b32 v9, v27 offset:8960
  ds_write_b32 v9, v28 offset:9216
  s_lshl_b32 s60, s63, 2
  v_mov_b32 v9, s60
  v_mov_b32 v10, 1
  ds_write_b32 v9, v10 offset:13440
  v_bfe_u32 v12, v0, 3, 1
  v_mul_u32_u24 v12, 1280, v12
  v_lshrrev_b32 v13, 4, v0
  v_lshlrev_b32 v13, 1, v13
  v_add_u32 v12, v12, v13
  s_lshl_b32 s60, s56, 1
  v_add_u32 v12, s60, v12
  v_and_b32 v14, 3, v0
  v_lshlrev_b32 v14, 2, v14
  s_mov_b32 s61, 0x1000000
L_fl_77:
  ds_read_b32 v15, v14 offset:13440
  s_waitcnt lgkmcnt(0)
  v_cmp_ne_u32 vcc, 1, v15
  s_nop 3
  s_cbranch_vccz L_fld_78
  s_sub_u32 s61, s61, 1
  s_cmp_lg_u32 s61, 0
  s_cbranch_scc1 L_fl_77
L_fld_78:
  ds_read_u16 v40, v12 offset:8192
  ds_read_u16 v41, v12 offset:8200
  ds_read_u16 v42, v12 offset:8208
  ds_read_u16 v43, v12 offset:8216
  ds_read_u16 v44, v12 offset:8224
  ds_read_u16 v45, v12 offset:10752
  ds_read_u16 v46, v12 offset:10760
  ds_read_u16 v47, v12 offset:10768
  ds_read_u16 v48, v12 offset:10776
  ds_read_u16 v49, v12 offset:10784
  v_bfe_u32 v9, v0, 3, 1
  v_lshlrev_b32 v9, 9, v9
  v_lshrrev_b32 v10, 4, v0
  v_lshlrev_b32 v10, 7, v10
  v_and_b32 v11, 7, v0
  v_lshlrev_b32 v11, 2, v11
  v_add3_u32 v9, v9, v10, v11
  s_lshl_b32 s60, s63, 11
  v_add_u32 v9, s60, v9
  s_waitcnt lgkmcnt(0)
  v_lshl_or_b32 v40, v40, 16, v40
  v_lshl_or_b32 v41, v41, 16, v41
  v_lshl_or_b32 v42, v42, 16, v42
  v_lshl_or_b32 v43, v43, 16, v43
  v_lshl_or_b32 v44, v44, 16, v44
  v_lshl_or_b32 v45, v45, 16, v45
  v_lshl_or_b32 v46, v46, 16, v46
  v_lshl_or_b32 v47, v47, 16, v47
  v_lshl_or_b32 v48, v48, 16, v48
  v_lshl_or_b32 v49, v49, 16, v49
  s_waitcnt vmcnt(0)
  v_and_b32 v60, v40, v4
  v_and_b32 v61, v40, v5
  v_and_b32 v62, v40, v6
  v_and_b32 v63, v40, v7
  s_nop 1
  v_mfma_f32_16x16x32_bf16 v[52:55], v[96:99], v[60:63], 0
  v_and_b32 v64, v45, v4
  v_and_b32 v65, v45, v5
  v_and_b32 v66, v45, v6
  v_and_b32 v67, v45, v7
  s_nop 1
  v_mfma_f32_16x16x32_bf16 v[56:59], v[96:99], v[64:67], 0
  v_and_b32 v68, v41, v4
  v_and_b32 v69, v41, v5
  v_and_b32 v70, v41, v6
  v_and_b32 v71, v41, v7
  s_nop 1
  v_mfma_f32_16x16x32_bf16 v[52:55], v[100:103], v[68:71], v[52:55]
  v_and_b32 v72, v46, v4
  v_and_b32 v73, v46, v5
  v_and_b32 v74, v46, v6
  v_and_b32 v75, v46, v7
  s_nop 1
  v_mfma_f32_16x16x32_bf16 v[56:59], v[100:103], v[72:75], v[56:59]
  v_and_b32 v60, v42, v4
  v_and_b32 v61, v42, v5
  v_and_b32 v62, v42, v6
  v_and_b32 v63, v42, v7
  s_nop 1
  v_mfma_f32_16x16x32_bf16 v[52:55], v[104:107], v[60:63], v[52:55]
  v_and_b32 v64, v47, v4
  v_and_b32 v65, v47, v5
  v_and_b32 v66, v47, v6
  v_and_b32 v67, v47, v7
  s_nop 1
  v_mfma_f32_16x16x32_bf16 v[56:59], v[104:107], v[64:67], v[56:59]
  v_and_b32 v68, v43, v4
  v_and_b32 v69, v43, v5
  v_and_b32 v70, v43, v6
  v_and_b32 v71, v43, v7
  s_nop 1
  v_mfma_f32_16x16x32_bf16 v[52:55], v[108:111], v[68:71], v[52:55]
  v_and_b32 v72, v48, v4
  v_and_b32 v73, v48, v5
  v_and_b32 v74, v48, v6
  v_and_b32 v75, v48, v7
  s_nop 1
  v_mfma_f32_16x16x32_bf16 v[56:59], v[108:111], v[72:75], v[56:59]
  v_and_b32 v60, v44, v4
  v_and_b32 v61, v44, v5
  v_and_b32 v62, v44, v6
  v_and_b32 v63, v44, v7
  s_nop 1
  v_mfma_f32_16x16x32_bf16 v[52:55], v[112:115], v[60:63], v[52:55]
  v_and_b32 v64, v49, v4
  v_and_b32 v65, v49, v5
  v_and_b32 v66, v49, v6
  v_and_b32 v67, v49, v7
  s_nop 1
  v_mfma_f32_16x16x32_bf16 v[56:59], v[112:115], v[64:67], v[56:59]
  s_nop 0
  ds_write_b32 v9, v52 offset:0
  ds_write_b32 v9, v53 offset:32
  ds_write_b32 v9, v54 offset:64
  ds_write_b32 v9, v55 offset:96
  s_nop 2
  ds_write_b32 v9, v56 offset:1024
  ds_write_b32 v9, v57 offset:1056
  ds_write_b32 v9, v58 offset:1088
  ds_write_b32 v9, v59 offset:1120
  s_lshl_b32 s60, s63, 2
  v_mov_b32 v10, s60
  v_mov_b32 v11, 1
  ds_write_b32 v10, v11 offset:13456
  s_lshl_b32 s69, s64, 2
  s_add_u32 s69, s69, s63
  s_lshl_b32 s69, s69, 3
  s_add_u32 s69, s69, s57
  s_lshl_b32 s62, s69, 9
  s_add_u32 s62, s62, 0x180000
  v_lshlrev_b32 v13, 3, v0
  s_lshl_b32 s60, s63, 9
  v_add_u32 v12, s60, v13
  v_and_b32 v14, 3, v0
  v_lshlrev_b32 v14, 2, v14
  s_mov_b32 s61, 0x1000000
L_fl_79:
  ds_read_b32 v15, v14 offset:13456
  s_waitcnt lgkmcnt(0)
  v_cmp_ne_u32 vcc, 1, v15
  s_nop 3
  s_cbranch_vccz L_fld_80
  s_sub_u32 s61, s61, 1
  s_cmp_lg_u32 s61, 0
  s_cbranch_scc1 L_fl_79
L_fld_80:
  ds_read_b64 v[16:17], v12 offset:0
  ds_read_b64 v[18:19], v12 offset:2048
  ds_read_b64 v[20:21], v12 offset:4096
  ds_read_b64 v[22:23], v12 offset:6144
  s_waitcnt lgkmcnt(0)
  v_add_f32 v16, v16, v18
  v_add_f32 v17, v17, v19
  v_add_f32 v20, v20, v22
  v_add_f32 v21, v21, v23
  v_add_f32 v24, v16, v20
  v_add_f32 v25, v17, v21
  buffer_store_dwordx2 v[24:25], v13, s[44:47], s62 offen sc1
  s_lshr_b32 s62, s69, 3
  s_lshl_b32 s62, s62, 7
  s_lshl_b32 s61, s57, 2
  s_add_u32 s62, s62, s61
  s_add_u32 s62, s62, 0x150000
  v_mov_b32 v14, 0
  s_waitcnt vmcnt(0)
  v_mov_b32 v15, s58
  s_mov_b64 exec, 1
  buffer_store_dword v15, v14, s[44:47], s62 offen sc1
  s_mov_b64 exec, -1
  s_cmp_lg_u32 s63, 0
  s_cbranch_scc1 L_noq_81
  s_lshl_b32 s69, s64, 2
  s_add_u32 s69, s69, s65
  s_lshl_b32 s60, s69, 7
  s_add_u32 s60, s60, 0x150000
  s_add_u32 s4, s30, s60
  s_addc_u32 s5, s31, 0
  s_mov_b32 s61, 0x200000
L_sp_82:
  s_load_dwordx8 s[76:83], s[4:5], 0 glc
  s_waitcnt lgkmcnt(0)
  s_xor_b32 s6, s76, s58
  s_xor_b32 s7, s77, s58
  s_or_b32 s6, s6, s7
  s_xor_b32 s7, s78, s58
  s_or_b32 s6, s6, s7
  s_xor_b32 s7, s79, s58
  s_or_b32 s6, s6, s7
  s_xor_b32 s7, s80, s58
  s_or_b32 s6, s6, s7
  s_xor_b32 s7, s81, s58
  s_or_b32 s6, s6, s7
  s_xor_b32 s7, s82, s58
  s_or_b32 s6, s6, s7
  s_xor_b32 s7, s83, s58
  s_or_b32 s6, s6, s7
  s_cmp_eq_u32 s6, 0
  s_cbranch_scc1 L_spd_83
  s_sleep 1
  s_sub_u32 s61, s61, 1
  s_cmp_lg_u32 s61, 0
  s_cbranch_scc1 L_sp_82
L_spd_83:
  s_lshl_b32 s60, s69, 12
  s_add_u32 s60, s60, 0x180000
  v_lshlrev_b32 v13, 4, v0
  buffer_load_dwordx4 v[16:19], v13, s[44:47], s60 offen offset:0 sc1
  buffer_load_dwordx4 v[20:23], v13, s[44:47], s60 offen offset:1024 sc1
  buffer_load_dwordx4 v[24:27], v13, s[44:47], s60 offen offset:2048 sc1
  buffer_load_dwordx4 v[28:31], v13, s[44:47], s60 offen offset:3072 sc1
  v_and_b32 v12, 31, v0
  v_lshlrev_b32 v12, 3, v12
  s_waitcnt vmcnt(0)
  v_add_f32 v16, v16, v20
  v_add_f32 v24, v24, v28
  v_add_f32 v17, v17, v21
  v_add_f32 v25, v25, v29
  v_add_f32 v18, v18, v22
  v_add_f32 v26, v26, v30
  v_add_f32 v19, v19, v23
  v_add_f32 v27, v27, v31
  v_add_f32 v16, v16, v24
  v_add_f32 v17, v17, v25
  v_add_f32 v18, v18, v26
  v_add_f32 v19, v19, v27
  v_mov_b32 v20, v16
  v_mov_b32 v21, v17
  v_mov_b32 v22, v18
  v_mov_b32 v23, v19
  v_permlane32_swap_b32 v16, v20
  v_permlane32_swap_b32 v17, v21
  v_permlane32_swap_b32 v18, v22
  v_permlane32_swap_b32 v19, v23
  v_add_f32 v16, v16, v20
  v_add_f32 v17, v17, v21
  v_add_f32 v18, v18, v22
  v_add_f32 v19, v19, v23
  v_cvt_pk_bf16_f32 v16, v16, v17
  v_cvt_pk_bf16_f32 v17, v18, v19
  ds_write_b64 v12, v[16:17] offset:13568
L_noq_81:
  s_waitcnt lgkmcnt(0)
  s_barrier
  s_cmp_lg_u32 s66, 0
  s_cbranch_scc1 L_wo_84
  s_and_b32 s70, s2, 7
  s_lshl_b32 s61, s65, 3
  s_add_u32 s70, s70, s61
  s_cmp_ge_u32 s70, 27
  s_cbranch_scc1 L_wo_84
  s_lshr_b32 s71, s2, 3
  s_and_b32 s71, s71, 3
  s_lshl_b32 s68, s70, 2
  s_add_u32 s68, s68, s71
  s_mov_b32 s48, s20
  s_and_b32 s49, s21, 0xffff
  s_mov_b32 s50, 0x21c000
  s_mov_b32 s51, 0x20000
  s_mov_b32 s52, s22
  s_and_b32 s53, s23, 0xffff
  s_mov_b32 s54, 0x21c000
  s_mov_b32 s55, 0x20000
  s_mov_b32 s72, s24
  s_and_b32 s73, s25, 0xffff
  s_mov_b32 s74, 0x21c000
  s_mov_b32 s75, 0x20000
  v_lshrrev_b32 v9, 3, v0
  v_mul_u32_u24 v9, 3456, v9
  v_and_b32 v10, 7, v0
  v_lshlrev_b32 v10, 4, v10
  v_add_u32 v9, v9, v10
  s_mul_i32 s60, s71, 552960
  s_lshl_b32 s61, s70, 7
  s_add_u32 s60, s60, s61
  s_mul_i32 s61, s63, 138240
  s_add_u32 s60, s60, s61
  s_mul_i32 s62, s63, 5120
  s_add_u32 s69, s62, 47104
  s_add_u32 s62, s62, 26624
  s_mov_b32 m0, s62
  s_nop 0
  buffer_load_dwordx4 v9, s[48:51], s60 offen  lds
  s_mov_b32 m0, s69
  s_nop 0
  buffer_load_dwordx4 v9, s[52:55], s60 offen  lds
  s_add_u32 s60, s60, 27648
  s_add_u32 s62, s62, 1024
  s_add_u32 s69, s69, 1024
  s_mov_b32 m0, s62
  s_nop 0
  buffer_load_dwordx4 v9, s[48:51], s60 offen  lds
  s_mov_b32 m0, s69
  s_nop 0
  buffer_load_dwordx4 v9, s[52:55], s60 offen  lds
  s_add_u32 s60, s60, 27648
  s_add_u32 s62, s62, 1024
  s_add_u32 s69, s69, 1024
  s_mov_b32 m0, s62
  s_nop 0
  buffer_load_dwordx4 v9, s[48:51], s60 offen  lds
  s_waitcnt vmcnt(4)
  s_mov_b32 m0, s69
  s_nop 0
  buffer_load_dwordx4 v9, s[52:55], s60 offen  lds
  s_add_u32 s60, s60, 27648
  s_add_u32 s62, s62, 1024
  s_add_u32 s69, s69, 1024
  s_waitcnt vmcnt(4)
  s_mov_b32 m0, s62
  s_nop 0
  buffer_load_dwordx4 v9, s[48:51], s60 offen  lds
  s_waitcnt vmcnt(4)
  s_mov_b32 m0, s69
  s_nop 0
  buffer_load_dwordx4 v9, s[52:55], s60 offen  lds
  s_add_u32 s60, s60, 27648
  s_add_u32 s62, s62, 1024
  s_add_u32 s69, s69, 1024
  s_waitcnt vmcnt(4)
  s_mov_b32 m0, s62
  s_nop 0
  buffer_load_dwordx4 v9, s[48:51], s60 offen  lds
  s_waitcnt vmcnt(4)
  s_mov_b32 m0, s69
  s_nop 0
  buffer_load_dwordx4 v9, s[52:55], s60 offen  lds
  s_cmp_eq_u32 s63, 0
  s_cbranch_scc1 L_w4_85
  s_waitcnt vmcnt(0)
  s_lshl_b32 s60, s63, 2
  v_mov_b32 v10, s60
  v_mov_b32 v11, 1
  ds_write_b32 v10, v11 offset:13472
  s_branch L_wo_84
L_w4_85:
  s_mov_b32 s59, 1
  v_and_b32 v9, 3, v0
  v_mul_u32_u24 v9, 1280, v9
  v_lshrrev_b32 v10, 4, v0
  v_lshlrev_b32 v11, 3, v10
  v_add_u32 v9, v9, v11
  s_mul_i32 s60, s71, 320
  v_add_u32 v9, s60, v9
  v_lshlrev_b32 v10, 2, v10
  v_bfe_u32 v11, v0, 2, 2
  v_add_u32 v10, v10, v11
  v_lshlrev_b32 v10, 7, v10
  v_and_b32 v11, 3, v0
  v_lshlrev_b32 v11, 3, v11
  v_add_u32 v10, v10, v11
  v_add_u32 v8, 20480, v10
  s_waitcnt vmcnt(0)
  v_mov_b32 v12, 0
  v_mov_b32 v13, 1
  ds_write_b32 v12, v13 offset:13472
  v_and_b32 v14, 3, v0
  v_lshlrev_b32 v14, 2, v14
  s_mov_b32 s61, 0x1000000
L_fl_86:
  ds_read_b32 v15, v14 offset:13472
  s_waitcnt lgkmcnt(0)
  v_cmp_ne_u32 vcc, 1, v15
  s_nop 3
  s_cbranch_vccz L_fld_87
  s_sub_u32 s61, s61, 1
  s_cmp_lg_u32 s61, 0
  s_cbranch_scc1 L_fl_86
L_fld_87:
  ds_read_b64 v[44:45], v9 offset:8192
  ds_read_b64 v[46:47], v9 offset:8224
  ds_read_b64_tr_b16 v[48:49], v10 offset:26624
  ds_read_b64_tr_b16 v[50:51], v10 offset:28672
  ds_read_b64_tr_b16 v[52:53], v8 offset:26624
  ds_read_b64_tr_b16 v[54:55], v8 offset:28672
  ds_read_b64_tr_b16 v[56:57], v10 offset:26656
  ds_read_b64_tr_b16 v[58:59], v10 offset:28704
  ds_read_b64_tr_b16 v[60:61], v8 offset:26656
  ds_read_b64_tr_b16 v[62:63], v8 offset:28704
  ds_read_b64_tr_b16 v[64:65], v10 offset:26688
  ds_read_b64_tr_b16 v[66:67], v10 offset:28736
  ds_read_b64_tr_b16 v[68:69], v8 offset:26688
  ds_read_b64_tr_b16 v[70:71], v8 offset:28736
  s_waitcnt lgkmcnt(6)
  ds_read_b64_tr_b16 v[72:73], v10 offset:26720
  ds_read_b64_tr_b16 v[74:75], v10 offset:28768
  ds_read_b64_tr_b16 v[76:77], v8 offset:26720
  ds_read_b64_tr_b16 v[78:79], v8 offset:28768
  s_waitcnt lgkmcnt(0)
  v_mfma_f32_16x16x32_bf16 v[12:15], v[44:47], v[48:51], 0
  v_mfma_f32_16x16x32_bf16 v[28:31], v[44:47], v[52:55], 0
  v_mfma_f32_16x16x32_bf16 v[16:19], v[44:47], v[56:59], 0
  v_mfma_f32_16x16x32_bf16 v[32:35], v[44:47], v[60:63], 0
  v_mfma_f32_16x16x32_bf16 v[20:23], v[44:47], v[64:67], 0
  v_mfma_f32_16x16x32_bf16 v[36:39], v[44:47], v[68:71], 0
  v_mfma_f32_16x16x32_bf16 v[24:27], v[44:47], v[72:75], 0
  v_mfma_f32_16x16x32_bf16 v[40:43], v[44:47], v[76:79], 0
  ds_read_b64 v[44:45], v9 offset:8256
  ds_read_b64 v[46:47], v9 offset:8288
  ds_read_b64_tr_b16 v[48:49], v10 offset:30720
  ds_read_b64_tr_b16 v[50:51], v10 offset:32768
  ds_read_b64_tr_b16 v[52:53], v8 offset:30720
  ds_read_b64_tr_b16 v[54:55], v8 offset:32768
  ds_read_b64_tr_b16 v[56:57], v10 offset:30752
  ds_read_b64_tr_b16 v[58:59], v10 offset:32800
  ds_read_b64_tr_b16 v[60:61], v8 offset:30752
  ds_read_b64_tr_b16 v[62:63], v8 offset:32800
  ds_read_b64_tr_b16 v[64:65], v10 offset:30784
  ds_read_b64_tr_b16 v[66:67], v10 offset:32832
  ds_read_b64_tr_b16 v[68:69], v8 offset:30784
  ds_read_b64_tr_b16 v[70:71], v8 offset:32832
  s_waitcnt lgkmcnt(6)
  ds_read_b64_tr_b16 v[72:73], v10 offset:30816
  ds_read_b64_tr_b16 v[74:75], v10 offset:32864
  ds_read_b64_tr_b16 v[76:77], v8 offset:30816
  ds_read_b64_tr_b16 v[78:79], v8 offset:32864
  s_waitcnt lgkmcnt(0)
  v_mfma_f32_16x16x32_bf16 v[12:15], v[44:47], v[48:51], v[12:15]
  v_mfma_f32_16x16x32_bf16 v[28:31], v[44:47], v[52:55], v[28:31]
  v_mfma_f32_16x16x32_bf16 v[16:19], v[44:47], v[56:59], v[16:19]
  v_mfma_f32_16x16x32_bf16 v[32:35], v[44:47], v[60:63], v[32:35]
  v_mfma_f32_16x16x32_bf16 v[20:23], v[44:47], v[64:67], v[20:23]
  v_mfma_f32_16x16x32_bf16 v[36:39], v[44:47], v[68:71], v[36:39]
  v_mfma_f32_16x16x32_bf16 v[24:27], v[44:47], v[72:75], v[24:27]
  v_mfma_f32_16x16x32_bf16 v[40:43], v[44:47], v[76:79], v[40:43]
  ds_read_b64 v[44:45], v9 offset:8320
  ds_read_b64 v[46:47], v9 offset:8352
  ds_read_b64_tr_b16 v[48:49], v10 offset:34816
  ds_read_b64_tr_b16 v[50:51], v10 offset:36864
  ds_read_b64_tr_b16 v[52:53], v8 offset:34816
  ds_read_b64_tr_b16 v[54:55], v8 offset:36864
  ds_read_b64_tr_b16 v[56:57], v10 offset:34848
  ds_read_b64_tr_b16 v[58:59], v10 offset:36896
  ds_read_b64_tr_b16 v[60:61], v8 offset:34848
  ds_read_b64_tr_b16 v[62:63], v8 offset:36896
  ds_read_b64_tr_b16 v[64:65], v10 offset:34880
  ds_read_b64_tr_b16 v[66:67], v10 offset:36928
  ds_read_b64_tr_b16 v[68:69], v8 offset:34880
  ds_read_b64_tr_b16 v[70:71], v8 offset:36928
  s_waitcnt lgkmcnt(6)
  ds_read_b64_tr_b16 v[72:73], v10 offset:34912
  ds_read_b64_tr_b16 v[74:75], v10 offset:36960
  ds_read_b64_tr_b16 v[76:77], v8 offset:34912
  ds_read_b64_tr_b16 v[78:79], v8 offset:36960
  s_waitcnt lgkmcnt(0)
  v_mfma_f32_16x16x32_bf16 v[12:15], v[44:47], v[48:51], v[12:15]
  v_mfma_f32_16x16x32_bf16 v[28:31], v[44:47], v[52:55], v[28:31]
  v_mfma_f32_16x16x32_bf16 v[16:19], v[44:47], v[56:59], v[16:19]
  v_mfma_f32_16x16x32_bf16 v[32:35], v[44:47], v[60:63], v[32:35]
  v_mfma_f32_16x16x32_bf16 v[20:23], v[44:47], v[64:67], v[20:23]
  v_mfma_f32_16x16x32_bf16 v[36:39], v[44:47], v[68:71], v[36:39]
  v_mfma_f32_16x16x32_bf16 v[24:27], v[44:47], v[72:75], v[24:27]
  v_mfma_f32_16x16x32_bf16 v[40:43], v[44:47], v[76:79], v[40:43]
  ds_read_b64 v[44:45], v9 offset:8384
  ds_read_b64 v[46:47], v9 offset:8416
  ds_read_b64_tr_b16 v[48:49], v10 offset:38912
  ds_read_b64_tr_b16 v[50:51], v10 offset:40960
  ds_read_b64_tr_b16 v[52:53], v8 offset:38912
  ds_read_b64_tr_b16 v[54:55], v8 offset:40960
  ds_read_b64_tr_b16 v[56:57], v10 offset:38944
  ds_read_b64_tr_b16 v[58:59], v10 offset:40992
  ds_read_b64_tr_b16 v[60:61], v8 offset:38944
  ds_read_b64_tr_b16 v[62:63], v8 offset:40992
  ds_read_b64_tr_b16 v[64:65], v10 offset:38976
  ds_read_b64_tr_b16 v[66:67], v10 offset:41024
  ds_read_b64_tr_b16 v[68:69], v8 offset:38976
  ds_read_b64_tr_b16 v[70:71], v8 offset:41024
  s_waitcnt lgkmcnt(6)
  ds_read_b64_tr_b16 v[72:73], v10 offset:39008
  ds_read_b64_tr_b16 v[74:75], v10 offset:41056
  ds_read_b64_tr_b16 v[76:77], v8 offset:39008
  ds_read_b64_tr_b16 v[78:79], v8 offset:41056
  s_waitcnt lgkmcnt(0)
  v_mfma_f32_16x16x32_bf16 v[12:15], v[44:47], v[48:51], v[12:15]
  v_mfma_f32_16x16x32_bf16 v[28:31], v[44:47], v[52:55], v[28:31]
  v_mfma_f32_16x16x32_bf16 v[16:19], v[44:47], v[56:59], v[16:19]
  v_mfma_f32_16x16x32_bf16 v[32:35], v[44:47], v[60:63], v[32:35]
  v_mfma_f32_16x16x32_bf16 v[20:23], v[44:47], v[64:67], v[20:23]
  v_mfma_f32_16x16x32_bf16 v[36:39], v[44:47], v[68:71], v[36:39]
  v_mfma_f32_16x16x32_bf16 v[24:27], v[44:47], v[72:75], v[24:27]
  v_mfma_f32_16x16x32_bf16 v[40:43], v[44:47], v[76:79], v[40:43]
  ds_read_b64 v[44:45], v9 offset:8448
  ds_read_b64 v[46:47], v9 offset:8480
  ds_read_b64_tr_b16 v[48:49], v10 offset:43008
  ds_read_b64_tr_b16 v[50:51], v10 offset:45056
  ds_read_b64_tr_b16 v[52:53], v8 offset:43008
  ds_read_b64_tr_b16 v[54:55], v8 offset:45056
  ds_read_b64_tr_b16 v[56:57], v10 offset:43040
  ds_read_b64_tr_b16 v[58:59], v10 offset:45088
  ds_read_b64_tr_b16 v[60:61], v8 offset:43040
  ds_read_b64_tr_b16 v[62:63], v8 offset:45088
  ds_read_b64_tr_b16 v[64:65], v10 offset:43072
  ds_read_b64_tr_b16 v[66:67], v10 offset:45120
  ds_read_b64_tr_b16 v[68:69], v8 offset:43072
  ds_read_b64_tr_b16 v[70:71], v8 offset:45120
  s_waitcnt lgkmcnt(6)
  ds_read_b64_tr_b16 v[72:73], v10 offset:43104
  ds_read_b64_tr_b16 v[74:75], v10 offset:45152
  ds_read_b64_tr_b16 v[76:77], v8 offset:43104
  ds_read_b64_tr_b16 v[78:79], v8 offset:45152
  s_waitcnt lgkmcnt(0)
  v_mfma_f32_16x16x32_bf16 v[12:15], v[44:47], v[48:51], v[12:15]
  v_mfma_f32_16x16x32_bf16 v[28:31], v[44:47], v[52:55], v[28:31]
  v_mfma_f32_16x16x32_bf16 v[16:19], v[44:47], v[56:59], v[16:19]
  v_mfma_f32_16x16x32_bf16 v[32:35], v[44:47], v[60:63], v[32:35]
  v_mfma_f32_16x16x32_bf16 v[20:23], v[44:47], v[64:67], v[20:23]
  v_mfma_f32_16x16x32_bf16 v[36:39], v[44:47], v[68:71], v[36:39]
  v_mfma_f32_16x16x32_bf16 v[24:27], v[44:47], v[72:75], v[24:27]
  v_mfma_f32_16x16x32_bf16 v[40:43], v[44:47], v[76:79], v[40:43]
  s_mov_b32 s76, 0xffff0000
  s_mov_b32 s77, 0
  s_mov_b32 s78, 0
  s_mov_b32 s79, 0xffff
  s_mov_b32 s80, 0
  s_mov_b32 s81, 0xffff0000
  v_lshlrev_b32 v9, 3, v0
  s_lshl_b32 s62, s70, 13
  s_lshl_b32 s69, s71, 9
  s_add_u32 s62, s62, s69
  s_add_u32 s62, s62, 0x320000
  v_cndmask_b32 v48, v12, v13, s[76:77]
  v_cndmask_b32 v48, v48, v14, s[78:79]
  v_cndmask_b32 v48, v48, v15, s[80:81]
  v_cndmask_b32 v49, v28, v29, s[76:77]
  v_cndmask_b32 v49, v49, v30, s[78:79]
  v_cndmask_b32 v49, v49, v31, s[80:81]
  buffer_store_dwordx2 v[48:49], v9, s[44:47], s62 offen sc1
  s_add_u32 s62, s62, 2048
  v_cndmask_b32 v50, v16, v17, s[76:77]
  v_cndmask_b32 v50, v50, v18, s[78:79]
  v_cndmask_b32 v50, v50, v19, s[80:81]
  v_cndmask_b32 v51, v32, v33, s[76:77]
  v_cndmask_b32 v51, v51, v34, s[78:79]
  v_cndmask_b32 v51, v51, v35, s[80:81]
  buffer_store_dwordx2 v[50:51], v9, s[44:47], s62 offen sc1
  s_add_u32 s62, s62, 2048
  v_cndmask_b32 v52, v20, v21, s[76:77]
  v_cndmask_b32 v52, v52, v22, s[78:79]
  v_cndmask_b32 v52, v52, v23, s[80:81]
  v_cndmask_b32 v53, v36, v37, s[76:77]
  v_cndmask_b32 v53, v53, v38, s[78:79]
  v_cndmask_b32 v53, v53, v39, s[80:81]
  buffer_store_dwordx2 v[52:53], v9, s[44:47], s62 offen sc1
  s_add_u32 s62, s62, 2048
  v_cndmask_b32 v54, v24, v25, s[76:77]
  v_cndmask_b32 v54, v54, v26, s[78:79]
  v_cndmask_b32 v54, v54, v27, s[80:81]
  v_cndmask_b32 v55, v40, v41, s[76:77]
  v_cndmask_b32 v55, v55, v42, s[78:79]
  v_cndmask_b32 v55, v55, v43, s[80:81]
  buffer_store_dwordx2 v[54:55], v9, s[44:47], s62 offen sc1
  v_lshrrev_b32 v2, 4, v0
  v_mul_u32_u24 v2, 1280, v2
  v_and_b32 v3, 15, v0
  v_lshlrev_b32 v3, 4, v3
  v_add_u32 v2, v2, v3
  s_mul_i32 s60, s68, 20480
  buffer_load_dwordx4 v[96:99], v2, s[72:75], s60 offen offset:0
  buffer_load_dwordx4 v[100:103], v2, s[72:75], s60 offen offset:256
  buffer_load_dwordx4 v[104:107], v2, s[72:75], s60 offen offset:512
  buffer_load_dwordx4 v[108:111], v2, s[72:75], s60 offen offset:768
  buffer_load_dwordx4 v[112:115], v2, s[72:75], s60 offen offset:1024
  s_add_u32 s60, s60, 5120
  buffer_load_dwordx4 v[116:119], v2, s[72:75], s60 offen offset:0
  buffer_load_dwordx4 v[120:123], v2, s[72:75], s60 offen offset:256
  buffer_load_dwordx4 v[124:127], v2, s[72:75], s60 offen offset:512
  buffer_load_dwordx4 v[128:131], v2, s[72:75], s60 offen offset:768
  buffer_load_dwordx4 v[132:135], v2, s[72:75], s60 offen offset:1024
  s_add_u32 s60, s60, 5120
  buffer_load_dwordx4 v[136:139], v2, s[72:75], s60 offen offset:0
  buffer_load_dwordx4 v[140:143], v2, s[72:75], s60 offen offset:256
  buffer_load_dwordx4 v[144:147], v2, s[72:75], s60 offen offset:512
  buffer_load_dwordx4 v[148:151], v2, s[72:75], s60 offen offset:768
  buffer_load_dwordx4 v[152:155], v2, s[72:75], s60 offen offset:1024
  s_add_u32 s60, s60, 5120
  buffer_load_dwordx4 v[156:159], v2, s[72:75], s60 offen offset:0
  buffer_load_dwordx4 v[160:163], v2, s[72:75], s60 offen offset:256
  buffer_load_dwordx4 v[164:167], v2, s[72:75], s60 offen offset:512
  buffer_load_dwordx4 v[168:171], v2, s[72:75], s60 offen offset:768
  buffer_load_dwordx4 v[172:175], v2, s[72:75], s60 offen offset:1024
  s_lshl_b32 s62, s70, 9
  s_lshl_b32 s69, s71, 2
  s_add_u32 s62, s62, s69
  s_add_u32 s62, s62, 0x158000
  v_lshlrev_b32 v14, 7, v0
  s_waitcnt vmcnt(20)
  v_mov_b32 v15, s58
  s_mov_b64 exec, 0xf
  buffer_store_dword v15, v14, s[44:47], s62 offen sc1
  s_mov_b64 exec, -1
  s_lshl_b32 s60, s68, 7
  s_add_u32 s60, s60, 0x158000
  s_add_u32 s4, s30, s60
  s_addc_u32 s5, s31, 0
  s_mov_b32 s61, 0x200000
L_sp_88:
  s_load_dwordx4 s[76:79], s[4:5], 0 glc
  s_waitcnt lgkmcnt(0)
  s_xor_b32 s6, s76, s58
  s_xor_b32 s7, s77, s58
  s_or_b32 s6, s6, s7
  s_xor_b32 s7, s78, s58
  s_or_b32 s6, s6, s7
  s_xor_b32 s7, s79, s58
  s_or_b32 s6, s6, s7
  s_cmp_eq_u32 s6, 0
  s_cbranch_scc1 L_spd_89
  s_sleep 2
  s_sub_u32 s61, s61, 1
  s_cmp_lg_u32 s61, 0
  s_cbranch_scc1 L_sp_88
L_spd_89:
  s_lshl_b32 s60, s68, 11
  s_add_u32 s60, s60, 0x320000
  buffer_load_dwordx2 v[12:13], v9, s[44:47], s60 offen offset:0 sc1
  buffer_load_dwordx2 v[14:15], v9, s[44:47], s60 offen offset:512 sc1
  buffer_load_dwordx2 v[16:17], v9, s[44:47], s60 offen offset:1024 sc1
  buffer_load_dwordx2 v[18:19], v9, s[44:47], s60 offen offset:1536 sc1
  s_waitcnt vmcnt(0)
  v_add_f32 v12, v12, v14
  v_add_f32 v16, v16, v18
  v_add_f32 v12, v12, v16
  v_add_f32 v13, v13, v15
  v_add_f32 v17, v17, v19
  v_add_f32 v14, v13, v17
  v_cvt_pk_bf16_f32 v12, v12, v12
  v_lshlrev_b32 v12, 16, v12
  v_cvt_pk_bf16_f32 v14, v14, v14
  v_lshlrev_b32 v14, 16, v14
  v_mul_f32 v20, v12, v12
  v_mul_f32 v20, v20, v12
  v_mov_b32 v21, 0x3d372713
  v_fma_f32 v20, v20, v21, v12
  v_mul_f32 v20, 0x3f4c422a, v20
  v_mul_f32 v20, 0x4038aa3b, v20
  v_exp_f32 v20, v20
  s_nop 0
  v_add_f32 v20, 1.0, v20
  v_rcp_f32 v20, v20
  s_nop 0
  v_fma_f32 v20, v20, -2.0, 1.0
  v_add_f32 v20, 1.0, v20
  v_mul_f32 v21, 0.5, v12
  v_mul_f32 v20, v21, v20
  v_cvt_pk_bf16_f32 v20, v20, v20
  v_lshlrev_b32 v20, 16, v20
  v_mul_f32 v20, v20, v14
  v_cvt_pk_bf16_f32 v12, v20, v20
  v_lshrrev_b32 v9, 4, v0
  v_lshlrev_b32 v9, 6, v9
  v_and_b32 v10, 3, v0
  v_lshlrev_b32 v10, 4, v10
  v_bfe_u32 v11, v0, 2, 2
  v_lshlrev_b32 v11, 2, v11
  v_add3_u32 v9, v9, v10, v11
  ds_write_b32 v9, v12 offset:13824
  v_bfe_u32 v9, v0, 3, 1
  v_lshlrev_b32 v9, 2, v9
  v_lshrrev_b32 v10, 4, v0
  v_add_u32 v9, v9, v10
  v_lshlrev_b32 v9, 4, v9
  s_waitcnt lgkmcnt(0)
  ds_read_b128 v[12:15], v9 offset:13824
  ds_read_b128 v[16:19], v9 offset:13952
  v_bfe_u32 v9, v0, 3, 1
  v_mul_u32_u24 v9, 640, v9
  v_lshrrev_b32 v10, 4, v0
  v_lshlrev_b32 v10, 5, v10
  v_and_b32 v11, 7, v0
  v_add3_u32 v9, v9, v10, v11
  v_lshlrev_b32 v9, 2, v9
  s_waitcnt vmcnt(0) lgkmcnt(0)
  v_and_b32 v60, v12, v4
  v_and_b32 v61, v12, v5
  v_and_b32 v62, v12, v6
  v_and_b32 v63, v12, v7
  s_nop 1
  v_mfma_f32_16x16x32_bf16 v[20:23], v[96:99], v[60:63], 0
  v_mfma_f32_16x16x32_bf16 v[28:31], v[100:103], v[60:63], 0
  v_mfma_f32_16x16x32_bf16 v[36:39], v[104:107], v[60:63], 0
  v_mfma_f32_16x16x32_bf16 v[44:47], v[108:111], v[60:63], 0
  v_mfma_f32_16x16x32_bf16 v[52:55], v[112:115], v[60:63], 0
  v_and_b32 v64, v16, v4
  v_and_b32 v65, v16, v5
  v_and_b32 v66, v16, v6
  v_and_b32 v67, v16, v7
  s_nop 1
  v_mfma_f32_16x16x32_bf16 v[24:27], v[96:99], v[64:67], 0
  v_mfma_f32_16x16x32_bf16 v[32:35], v[100:103], v[64:67], 0
  v_mfma_f32_16x16x32_bf16 v[40:43], v[104:107], v[64:67], 0
  v_mfma_f32_16x16x32_bf16 v[48:51], v[108:111], v[64:67], 0
  v_mfma_f32_16x16x32_bf16 v[56:59], v[112:115], v[64:67], 0
  v_and_b32 v68, v13, v4
  v_and_b32 v69, v13, v5
  v_and_b32 v70, v13, v6
  v_and_b32 v71, v13, v7
  s_nop 1
  v_mfma_f32_16x16x32_bf16 v[20:23], v[116:119], v[68:71], v[20:23]
  v_mfma_f32_16x16x32_bf16 v[28:31], v[120:123], v[68:71], v[28:31]
  v_mfma_f32_16x16x32_bf16 v[36:39], v[124:127], v[68:71], v[36:39]
  v_mfma_f32_16x16x32_bf16 v[44:47], v[128:131], v[68:71], v[44:47]
  v_mfma_f32_16x16x32_bf16 v[52:55], v[132:135], v[68:71], v[52:55]
  v_and_b32 v72, v17, v4
  v_and_b32 v73, v17, v5
  v_and_b32 v74, v17, v6
  v_and_b32 v75, v17, v7
  s_nop 1
  v_mfma_f32_16x16x32_bf16 v[24:27], v[116:119], v[72:75], v[24:27]
  v_mfma_f32_16x16x32_bf16 v[32:35], v[120:123], v[72:75], v[32:35]
  v_mfma_f32_16x16x32_bf16 v[40:43], v[124:127], v[72:75], v[40:43]
  v_mfma_f32_16x16x32_bf16 v[48:51], v[128:131], v[72:75], v[48:51]
  v_mfma_f32_16x16x32_bf16 v[56:59], v[132:135], v[72:75], v[56:59]
  v_and_b32 v60, v14, v4
  v_and_b32 v61, v14, v5
  v_and_b32 v62, v14, v6
  v_and_b32 v63, v14, v7
  s_nop 1
  v_mfma_f32_16x16x32_bf16 v[20:23], v[136:139], v[60:63], v[20:23]
  v_mfma_f32_16x16x32_bf16 v[28:31], v[140:143], v[60:63], v[28:31]
  v_mfma_f32_16x16x32_bf16 v[36:39], v[144:147], v[60:63], v[36:39]
  v_mfma_f32_16x16x32_bf16 v[44:47], v[148:151], v[60:63], v[44:47]
  v_mfma_f32_16x16x32_bf16 v[52:55], v[152:155], v[60:63], v[52:55]
  v_and_b32 v64, v18, v4
  v_and_b32 v65, v18, v5
  v_and_b32 v66, v18, v6
  v_and_b32 v67, v18, v7
  s_nop 1
  v_mfma_f32_16x16x32_bf16 v[24:27], v[136:139], v[64:67], v[24:27]
  v_mfma_f32_16x16x32_bf16 v[32:35], v[140:143], v[64:67], v[32:35]
  v_mfma_f32_16x16x32_bf16 v[40:43], v[144:147], v[64:67], v[40:43]
  v_mfma_f32_16x16x32_bf16 v[48:51], v[148:151], v[64:67], v[48:51]
  v_mfma_f32_16x16x32_bf16 v[56:59], v[152:155], v[64:67], v[56:59]
  v_and_b32 v68, v15, v4
  v_and_b32 v69, v15, v5
  v_and_b32 v70, v15, v6
  v_and_b32 v71, v15, v7
  s_nop 1
  v_mfma_f32_16x16x32_bf16 v[20:23], v[156:159], v[68:71], v[20:23]
  v_mfma_f32_16x16x32_bf16 v[28:31], v[160:163], v[68:71], v[28:31]
  v_mfma_f32_16x16x32_bf16 v[36:39], v[164:167], v[68:71], v[36:39]
  v_mfma_f32_16x16x32_bf16 v[44:47], v[168:171], v[68:71], v[44:47]
  v_mfma_f32_16x16x32_bf16 v[52:55], v[172:175], v[68:71], v[52:55]
  v_and_b32 v72, v19, v4
  v_and_b32 v73, v19, v5
  v_and_b32 v74, v19, v6
  v_and_b32 v75, v19, v7
  s_nop 1
  v_mfma_f32_16x16x32_bf16 v[24:27], v[156:159], v[72:75], v[24:27]
  v_mfma_f32_16x16x32_bf16 v[32:35], v[160:163], v[72:75], v[32:35]
  v_mfma_f32_16x16x32_bf16 v[40:43], v[164:167], v[72:75], v[40:43]
  v_mfma_f32_16x16x32_bf16 v[48:51], v[168:171], v[72:75], v[48:51]
  v_mfma_f32_16x16x32_bf16 v[56:59], v[172:175], v[72:75], v[56:59]
  ds_write_b32 v9, v20 offset:16128
  ds_write_b32 v9, v21 offset:16160
  ds_write_b32 v9, v22 offset:16192
  ds_write_b32 v9, v23 offset:16224
  ds_write_b32 v9, v24 offset:21248
  ds_write_b32 v9, v25 offset:21280
  ds_write_b32 v9, v26 offset:21312
  ds_write_b32 v9, v27 offset:21344
  ds_write_b32 v9, v28 offset:16640
  ds_write_b32 v9, v29 offset:16672
  ds_write_b32 v9, v30 offset:16704
  ds_write_b32 v9, v31 offset:16736
  ds_write_b32 v9, v32 offset:21760
  ds_write_b32 v9, v33 offset:21792
  ds_write_b32 v9, v34 offset:21824
  ds_write_b32 v9, v35 offset:21856
  ds_write_b32 v9, v36 offset:17152
  ds_write_b32 v9, v37 offset:17184
  ds_write_b32 v9, v38 offset:17216
  ds_write_b32 v9, v39 offset:17248
  ds_write_b32 v9, v40 offset:22272
  ds_write_b32 v9, v41 offset:22304
  ds_write_b32 v9, v42 offset:22336
  ds_write_b32 v9, v43 offset:22368
  ds_write_b32 v9, v44 offset:17664
  ds_write_b32 v9, v45 offset:17696
  ds_write_b32 v9, v46 offset:17728
  ds_write_b32 v9, v47 offset:17760
  ds_write_b32 v9, v48 offset:22784
  ds_write_b32 v9, v49 offset:22816
  ds_write_b32 v9, v50 offset:22848
  ds_write_b32 v9, v51 offset:22880
  ds_write_b32 v9, v52 offset:18176
  ds_write_b32 v9, v53 offset:18208
  ds_write_b32 v9, v54 offset:18240
  ds_write_b32 v9, v55 offset:18272
  ds_write_b32 v9, v56 offset:23296
  ds_write_b32 v9, v57 offset:23328
  ds_write_b32 v9, v58 offset:23360
  ds_write_b32 v9, v59 offset:23392
  s_waitcnt lgkmcnt(0)
  v_lshlrev_b32 v9, 4, v0
  s_mul_i32 s60, s68, 10240
  s_add_u32 s60, s60, 0x200000
  ds_read_b128 v[12:15], v9 offset:16128
  ds_read_b128 v[16:19], v9 offset:17152
  ds_read_b128 v[20:23], v9 offset:18176
  ds_read_b128 v[24:27], v9 offset:19200
  ds_read_b128 v[28:31], v9 offset:20224
  ds_read_b128 v[32:35], v9 offset:21248
  ds_read_b128 v[36:39], v9 offset:22272
  ds_read_b128 v[40:43], v9 offset:23296
  ds_read_b128 v[44:47], v9 offset:24320
  ds_read_b128 v[48:51], v9 offset:25344
  s_waitcnt lgkmcnt(0)
  buffer_store_dwordx4 v[12:15], v9, s[44:47], s60 offen offset:0 sc1
  buffer_store_dwordx4 v[16:19], v9, s[44:47], s60 offen offset:1024 sc1
  buffer_store_dwordx4 v[20:23], v9, s[44:47], s60 offen offset:2048 sc1
  buffer_store_dwordx4 v[24:27], v9, s[44:47], s60 offen offset:3072 sc1
  s_add_u32 s60, s60, 4096
  buffer_store_dwordx4 v[28:31], v9, s[44:47], s60 offen offset:0 sc1
  buffer_store_dwordx4 v[32:35], v9, s[44:47], s60 offen offset:1024 sc1
  buffer_store_dwordx4 v[36:39], v9, s[44:47], s60 offen offset:2048 sc1
  buffer_store_dwordx4 v[40:43], v9, s[44:47], s60 offen offset:3072 sc1
  s_add_u32 s60, s60, 4096
  buffer_store_dwordx4 v[44:47], v9, s[44:47], s60 offen offset:0 sc1
  buffer_store_dwordx4 v[48:51], v9, s[44:47], s60 offen offset:1024 sc1
  s_lshl_b32 s62, s68, 2
  s_add_u32 s62, s62, 0x14b000
  v_mov_b32 v9, 0
  s_waitcnt vmcnt(0)
  v_mov_b32 v15, s58
  s_mov_b64 exec, 1
  buffer_store_dword v15, v9, s[44:47], s62 offen sc1
  s_mov_b64 exec, -1
L_wo_84:
  v_mov_b32 v14, 0
  s_mov_b32 s61, 0x400000
L_w1_90:
  ds_read_b32 v15, v14 offset:13492
  s_waitcnt lgkmcnt(0)
  v_cmp_eq_u32 vcc, 1, v15
  s_nop 3
  s_cbranch_vccnz L_w1d_91
  s_sleep 8
  s_sub_u32 s61, s61, 1
  s_cmp_lg_u32 s61, 0
  s_cbranch_scc1 L_w1_90
L_w1d_91:
  v_lshrrev_b32 v2, 4, v0
  v_mul_u32_u24 v2, 1280, v2
  v_and_b32 v3, 15, v0
  v_lshlrev_b32 v3, 4, v3
  v_add_u32 v2, v2, v3
  s_lshl_b32 s60, s64, 7
  s_lshl_b32 s61, s63, 5
  s_add_u32 s60, s60, s61
  s_mul_i32 s60, s60, 1280
  s_mov_b32 s7, s60
  s_mul_i32 s6, s57, 5120
  s_add_u32 s60, s7, s6
  s_cmp_eq_u32 s59, 1
  s_cbranch_scc1 L_wo4_92
  buffer_load_dwordx4 v[96:99], v2, s[36:39], s60 offen offset:0
  buffer_load_dwordx4 v[100:103], v2, s[36:39], s60 offen offset:256
  buffer_load_dwordx4 v[104:107], v2, s[36:39], s60 offen offset:512
  s_waitcnt vmcnt(2)
  buffer_load_dwordx4 v[108:111], v2, s[36:39], s60 offen offset:768
  s_waitcnt vmcnt(2)
  buffer_load_dwordx4 v[112:115], v2, s[36:39], s60 offen offset:1024
  s_add_u32 s6, s57, 1
  s_and_b32 s6, s6, 7
  s_mul_i32 s6, s6, 5120
  s_add_u32 s60, s7, s6
  s_waitcnt vmcnt(2)
  buffer_load_dwordx4 v[116:119], v2, s[36:39], s60 offen offset:0
  s_waitcnt vmcnt(2)
  buffer_load_dwordx4 v[120:123], v2, s[36:39], s60 offen offset:256
  s_waitcnt vmcnt(2)
  buffer_load_dwordx4 v[124:127], v2, s[36:39], s60 offen offset:512
  s_waitcnt vmcnt(2)
  buffer_load_dwordx4 v[128:131], v2, s[36:39], s60 offen offset:768
  s_waitcnt vmcnt(2)
  buffer_load_dwordx4 v[132:135], v2, s[36:39], s60 offen offset:1024
  s_add_u32 s6, s57, 2
  s_and_b32 s6, s6, 7
  s_mul_i32 s6, s6, 5120
  s_add_u32 s60, s7, s6
  s_waitcnt vmcnt(2)
  buffer_load_dwordx4 v[136:139], v2, s[36:39], s60 offen offset:0
  s_waitcnt vmcnt(2)
  buffer_load_dwordx4 v[140:143], v2, s[36:39], s60 offen offset:256
  s_waitcnt vmcnt(2)
  buffer_load_dwordx4 v[144:147], v2, s[36:39], s60 offen offset:512
  s_waitcnt vmcnt(2)
  buffer_load_dwordx4 v[148:151], v2, s[36:39], s60 offen offset:768
  s_waitcnt vmcnt(2)
  buffer_load_dwordx4 v[152:155], v2, s[36:39], s60 offen offset:1024
  s_add_u32 s6, s57, 3
  s_and_b32 s6, s6, 7
  s_mul_i32 s6, s6, 5120
  s_add_u32 s60, s7, s6
  s_waitcnt vmcnt(2)
  buffer_load_dwordx4 v[156:159], v2, s[36:39], s60 offen offset:0
  s_waitcnt vmcnt(2)
  buffer_load_dwordx4 v[160:163], v2, s[36:39], s60 offen offset:256
  s_waitcnt vmcnt(2)
  buffer_load_dwordx4 v[164:167], v2, s[36:39], s60 offen offset:512
  s_waitcnt vmcnt(2)
  buffer_load_dwordx4 v[168:171], v2, s[36:39], s60 offen offset:768
  s_waitcnt vmcnt(2)
  buffer_load_dwordx4 v[172:175], v2, s[36:39], s60 offen offset:1024
  s_add_u32 s6, s57, 4
  s_and_b32 s6, s6, 7
  s_mul_i32 s6, s6, 5120
  s_add_u32 s60, s7, s6
  s_waitcnt vmcnt(2)
  buffer_load_dwordx4 v[176:179], v2, s[36:39], s60 offen offset:0
  s_waitcnt vmcnt(2)
  buffer_load_dwordx4 v[180:183], v2, s[36:39], s60 offen offset:256
  s_waitcnt vmcnt(2)
  buffer_load_dwordx4 v[184:187], v2, s[36:39], s60 offen offset:512
  s_waitcnt vmcnt(2)
  buffer_load_dwordx4 v[188:191], v2, s[36:39], s60 offen offset:768
  s_waitcnt vmcnt(2)
  buffer_load_dwordx4 v[192:195], v2, s[36:39], s60 offen offset:1024
  s_add_u32 s6, s57, 5
  s_and_b32 s6, s6, 7
  s_mul_i32 s6, s6, 5120
  s_add_u32 s60, s7, s6
  s_waitcnt vmcnt(2)
  buffer_load_dwordx4 v[196:199], v2, s[36:39], s60 offen offset:0
  s_waitcnt vmcnt(2)
  buffer_load_dwordx4 v[200:203], v2, s[36:39], s60 offen offset:256
  s_waitcnt vmcnt(2)
  buffer_load_dwordx4 v[204:207], v2, s[36:39], s60 offen offset:512
  s_waitcnt vmcnt(2)
  buffer_load_dwordx4 v[208:211], v2, s[36:39], s60 offen offset:768
  s_waitcnt vmcnt(2)
  buffer_load_dwordx4 v[212:215], v2, s[36:39], s60 offen offset:1024
  s_add_u32 s6, s57, 6
  s_and_b32 s6, s6, 7
  s_mul_i32 s6, s6, 5120
  s_add_u32 s60, s7, s6
  s_waitcnt vmcnt(2)
  buffer_load_dwordx4 v[216:219], v2, s[36:39], s60 offen offset:0
  s_waitcnt vmcnt(2)
  buffer_load_dwordx4 v[220:223], v2, s[36:39], s60 offen offset:256
  s_waitcnt vmcnt(2)
  buffer_load_dwordx4 v[224:227], v2, s[36:39], s60 offen offset:512
  s_waitcnt vmcnt(2)
  buffer_load_dwordx4 v[228:231], v2, s[36:39], s60 offen offset:768
  s_waitcnt vmcnt(2)
  buffer_load_dwordx4 v[232:235], v2, s[36:39], s60 offen offset:1024
  s_add_u32 s6, s57, 7
  s_and_b32 s6, s6, 7
  s_mul_i32 s6, s6, 5120
  s_add_u32 s60, s7, s6
  s_waitcnt vmcnt(2)
  buffer_load_dwordx4 v[236:239], v2, s[36:39], s60 offen offset:0
  s_waitcnt vmcnt(2)
  buffer_load_dwordx4 v[240:243], v2, s[36:39], s60 offen offset:256
  s_waitcnt vmcnt(2)
  buffer_load_dwordx4 v[244:247], v2, s[36:39], s60 offen offset:512
  s_waitcnt vmcnt(2)
  buffer_load_dwordx4 v[248:251], v2, s[36:39], s60 offen offset:768
  s_waitcnt vmcnt(2)
  buffer_load_dwordx4 v[252:255], v2, s[36:39], s60 offen offset:1024
  s_branch L_wod_93
L_wo4_92:
  buffer_load_dwordx4 v[96:99], v2, s[36:39], s60 offen offset:0
  buffer_load_dwordx4 v[100:103], v2, s[36:39], s60 offen offset:256
  buffer_load_dwordx4 v[104:107], v2, s[36:39], s60 offen offset:512
  buffer_load_dwordx4 v[108:111], v2, s[36:39], s60 offen offset:768
  buffer_load_dwordx4 v[112:115], v2, s[36:39], s60 offen offset:1024
  s_add_u32 s6, s57, 1
  s_and_b32 s6, s6, 7
  s_mul_i32 s6, s6, 5120
  s_add_u32 s60, s7, s6
  s_waitcnt vmcnt(4)
  buffer_load_dwordx4 v[116:119], v2, s[36:39], s60 offen offset:0
  s_waitcnt vmcnt(4)
  buffer_load_dwordx4 v[120:123], v2, s[36:39], s60 offen offset:256
  s_waitcnt vmcnt(4)
  buffer_load_dwordx4 v[124:127], v2, s[36:39], s60 offen offset:512
  s_waitcnt vmcnt(4)
  buffer_load_dwordx4 v[128:131], v2, s[36:39], s60 offen offset:768
  s_waitcnt vmcnt(4)
  buffer_load_dwordx4 v[132:135], v2, s[36:39], s60 offen offset:1024
  s_add_u32 s6, s57, 2
  s_and_b32 s6, s6, 7
  s_mul_i32 s6, s6, 5120
  s_add_u32 s60, s7, s6
  s_waitcnt vmcnt(4)
  buffer_load_dwordx4 v[136:139], v2, s[36:39], s60 offen offset:0
  s_waitcnt vmcnt(4)
  buffer_load_dwordx4 v[140:143], v2, s[36:39], s60 offen offset:256
  s_waitcnt vmcnt(4)
  buffer_load_dwordx4 v[144:147], v2, s[36:39], s60 offen offset:512
  s_waitcnt vmcnt(4)
  buffer_load_dwordx4 v[148:151], v2, s[36:39], s60 offen offset:768
  s_waitcnt vmcnt(4)
  buffer_load_dwordx4 v[152:155], v2, s[36:39], s60 offen offset:1024
  s_add_u32 s6, s57, 3
  s_and_b32 s6, s6, 7
  s_mul_i32 s6, s6, 5120
  s_add_u32 s60, s7, s6
  s_waitcnt vmcnt(4)
  buffer_load_dwordx4 v[156:159], v2, s[36:39], s60 offen offset:0
  s_waitcnt vmcnt(4)
  buffer_load_dwordx4 v[160:163], v2, s[36:39], s60 offen offset:256
  s_waitcnt vmcnt(4)
  buffer_load_dwordx4 v[164:167], v2, s[36:39], s60 offen offset:512
  s_waitcnt vmcnt(4)
  buffer_load_dwordx4 v[168:171], v2, s[36:39], s60 offen offset:768
  s_waitcnt vmcnt(4)
  buffer_load_dwordx4 v[172:175], v2, s[36:39], s60 offen offset:1024
  s_add_u32 s6, s57, 4
  s_and_b32 s6, s6, 7
  s_mul_i32 s6, s6, 5120
  s_add_u32 s60, s7, s6
  s_waitcnt vmcnt(4)
  buffer_load_dwordx4 v[176:179], v2, s[36:39], s60 offen offset:0
  s_waitcnt vmcnt(4)
  buffer_load_dwordx4 v[180:183], v2, s[36:39], s60 offen offset:256
  s_waitcnt vmcnt(4)
  buffer_load_dwordx4 v[184:187], v2, s[36:39], s60 offen offset:512
  s_waitcnt vmcnt(4)
  buffer_load_dwordx4 v[188:191], v2, s[36:39], s60 offen offset:768
  s_waitcnt vmcnt(4)
  buffer_load_dwordx4 v[192:195], v2, s[36:39], s60 offen offset:1024
  s_add_u32 s6, s57, 5
  s_and_b32 s6, s6, 7
  s_mul_i32 s6, s6, 5120
  s_add_u32 s60, s7, s6
  s_waitcnt vmcnt(4)
  buffer_load_dwordx4 v[196:199], v2, s[36:39], s60 offen offset:0
  s_waitcnt vmcnt(4)
  buffer_load_dwordx4 v[200:203], v2, s[36:39], s60 offen offset:256
  s_waitcnt vmcnt(4)
  buffer_load_dwordx4 v[204:207], v2, s[36:39], s60 offen offset:512
  s_waitcnt vmcnt(4)
  buffer_load_dwordx4 v[208:211], v2, s[36:39], s60 offen offset:768
  s_waitcnt vmcnt(4)
  buffer_load_dwordx4 v[212:215], v2, s[36:39], s60 offen offset:1024
  s_add_u32 s6, s57, 6
  s_and_b32 s6, s6, 7
  s_mul_i32 s6, s6, 5120
  s_add_u32 s60, s7, s6
  s_waitcnt vmcnt(4)
  buffer_load_dwordx4 v[216:219], v2, s[36:39], s60 offen offset:0
  s_waitcnt vmcnt(4)
  buffer_load_dwordx4 v[220:223], v2, s[36:39], s60 offen offset:256
  s_waitcnt vmcnt(4)
  buffer_load_dwordx4 v[224:227], v2, s[36:39], s60 offen offset:512
  s_waitcnt vmcnt(4)
  buffer_load_dwordx4 v[228:231], v2, s[36:39], s60 offen offset:768
  s_waitcnt vmcnt(4)
  buffer_load_dwordx4 v[232:235], v2, s[36:39], s60 offen offset:1024
  s_add_u32 s6, s57, 7
  s_and_b32 s6, s6, 7
  s_mul_i32 s6, s6, 5120
  s_add_u32 s60, s7, s6
  s_waitcnt vmcnt(4)
  buffer_load_dwordx4 v[236:239], v2, s[36:39], s60 offen offset:0
  s_waitcnt vmcnt(4)
  buffer_load_dwordx4 v[240:243], v2, s[36:39], s60 offen offset:256
  s_waitcnt vmcnt(4)
  buffer_load_dwordx4 v[244:247], v2, s[36:39], s60 offen offset:512
  s_waitcnt vmcnt(4)
  buffer_load_dwordx4 v[248:251], v2, s[36:39], s60 offen offset:768
  s_waitcnt vmcnt(4)
  buffer_load_dwordx4 v[252:255], v2, s[36:39], s60 offen offset:1024
L_wod_93:
  s_cmp_eq_u32 s63, 3
  s_cbranch_scc1 L_w7_95
  s_cmp_lg_u32 s63, 2
  s_cbranch_scc1 L_nocol_96
  s_cmp_lg_u32 s2, 255
  s_cbranch_scc1 L_tail_94
  v_lshlrev_b32 v9, 2, v0
  s_mov_b32 s60, 0x14b000
  s_mov_b32 s61, 0x100000
L_fc_97:
  buffer_load_dword v10, v9, s[44:47], s60 offen sc1
  buffer_load_dword v11, v9, s[44:47], s60 offen offset:256 sc1
  s_waitcnt vmcnt(0)
  v_cmp_ne_u32 vcc, s58, v10
  v_cmp_ne_u32 s[76:77], s58, v11
  s_nop 0
  s_and_b32 s77, s77, 0xfff
  s_or_b64 vcc, vcc, s[76:77]
  s_nop 0
  s_cbranch_vccz L_fcd_98
  s_sleep 32
  s_sub_u32 s61, s61, 1
  s_cmp_lg_u32 s61, 0
  s_cbranch_scc1 L_fc_97
L_fcd_98:
  v_lshlrev_b32 v9, 7, v0
  v_mov_b32 v10, s58
  s_mov_b32 s60, 0x160000
  buffer_store_dword v10, v9, s[44:47], s60 offen sc1
  s_mov_b32 s60, 0x162000
  s_mov_b64 exec, 0xffff
  buffer_store_dword v10, v9, s[44:47], s60 offen sc1
  s_mov_b64 exec, -1
  s_branch L_tail_94
L_nocol_96:
  s_cmp_lg_u32 s63, 1
  s_cbranch_scc1 L_tail_94
  v_and_b32 v9, 3, v0
  v_lshlrev_b32 v9, 3, v9
  s_mov_b32 s61, 0x400000
L_ml_99:
  ds_read_b64 v[10:11], v9 offset:13312
  s_waitcnt lgkmcnt(0)
  v_cmp_eq_u32 vcc, -1, v10
  s_nop 3
  s_cbranch_vccz L_mld_100
  s_sleep 16
  s_sub_u32 s61, s61, 1
  s_cmp_lg_u32 s61, 0
  s_cbranch_scc1 L_ml_99
L_mld_100:
  v_mov_b32 v12, v10
  s_nop 1
  v_max_f32_dpp v12, v12, v12 quad_perm:[1,0,3,2] row_mask:0xf bank_mask:0xf
  s_nop 1
  v_max_f32_dpp v12, v12, v12 quad_perm:[2,3,0,1] row_mask:0xf bank_mask:0xf
  v_sub_f32 v14, v10, v12
  v_mul_f32 v14, 0x3fb8aa3b, v14
  v_exp_f32 v14, v14
  s_nop 0
  v_mul_f32 v14, v14, v11
  s_nop 1
  v_add_f32_dpp v14, v14, v14 quad_perm:[1,0,3,2] row_mask:0xf bank_mask:0xf
  s_nop 1
  v_add_f32_dpp v14, v14, v14 quad_perm:[2,3,0,1] row_mask:0xf bank_mask:0xf
  v_mov_b32 v13, s58
  v_mov_b32 v15, s58
  s_xor_b32 s60, s2, 128
  s_lshl_b32 s60, s60, 7
  s_add_u32 s60, s60, 0x140000
  v_mov_b32 v9, 0
  s_mov_b64 exec, 1
  buffer_store_dwordx4 v[12:15], v9, s[44:47], s60 offen sc1
  s_mov_b64 exec, -1
  s_lshl_b32 s60, s2, 7
  s_add_u32 s60, s60, 0x140000
  s_add_u32 s4, s30, s60
  s_addc_u32 s5, s31, 0
  s_mov_b32 s61, 0x200000
L_sp_101:
  s_load_dwordx4 s[76:79], s[4:5], 0 glc
  s_waitcnt lgkmcnt(0)
  s_xor_b32 s6, s77, s58
  s_xor_b32 s7, s79, s58
  s_or_b32 s6, s6, s7
  s_cmp_eq_u32 s6, 0
  s_cbranch_scc1 L_spd_102
  s_sleep 4
  s_sub_u32 s61, s61, 1
  s_cmp_lg_u32 s61, 0
  s_cbranch_scc1 L_sp_101
L_spd_102:
  v_mov_b32 v22, s76
  v_mov_b32 v23, s78
  v_max_f32 v16, v12, v22
  v_sub_f32 v17, v12, v16
  v_mul_f32 v17, 0x3fb8aa3b, v17
  v_exp_f32 v17, v17
  v_sub_f32 v18, v22, v16
  v_mul_f32 v18, 0x3fb8aa3b, v18
  v_exp_f32 v18, v18
  v_mul_f32 v17, v17, v14
  v_fma_f32 v17, v18, v23, v17
  v_sub_f32 v18, v10, v16
  v_mul_f32 v18, 0x3fb8aa3b, v18
  v_exp_f32 v18, v18
  v_rcp_f32 v19, v17
  s_nop 0
  v_mul_f32 v20, v18, v19
  v_fma_f32 v21, -v20, v17, v18
  v_fma_f32 v20, v21, v19, v20
  v_mov_b32 v14, 0x7fc00000
  v_cmp_eq_u32 vcc, -1, v20
  s_nop 1
  v_cndmask_b32 v20, v20, v14, vcc
  v_and_b32 v9, 3, v0
  v_lshlrev_b32 v9, 2, v9
  ds_write_b32 v9, v20 offset:13376
  s_waitcnt lgkmcnt(0)
  s_branch L_tail_94
L_w7_95:
  s_cmp_ge_u32 s84, 20
  s_cbranch_scc1 L_tail_94
  s_mul_i32 s60, s65, 20
  s_add_u32 s60, s60, s84
  s_lshl_b32 s60, s60, 7
  s_add_u32 s60, s60, 0x160000
  s_add_u32 s4, s30, s60
  s_addc_u32 s5, s31, 0
  s_mov_b32 s61, 0x200000
L_sp_103:
  s_load_dword s76, s[4:5], 0 glc
  s_waitcnt lgkmcnt(0)
  s_xor_b32 s6, s76, s58
  s_cmp_eq_u32 s6, 0
  s_cbranch_scc1 L_spd_104
  s_sleep 32
  s_sub_u32 s61, s61, 1
  s_cmp_lg_u32 s61, 0
  s_cbranch_scc1 L_sp_103
L_spd_104:
  v_lshrrev_b32 v9, 3, v0
  v_mul_u32_u24 v9, 10240, v9
  v_and_b32 v10, 7, v0
  v_lshlrev_b32 v10, 4, v10
  v_add_u32 v9, v9, v10
  s_mul_i32 s60, s65, 2560
  s_lshl_b32 s61, s84, 7
  s_add_u32 s60, s60, s61
  s_add_u32 s60, s60, 0x200000
  v_mov_b32 v68, 0
  v_mov_b32 v69, 0
  v_mov_b32 v70, 0
  v_mov_b32 v71, 0
  buffer_load_dwordx4 v[16:19], v9, s[44:47], s60 offen sc1
  s_add_u32 s60, s60, 81920
  buffer_load_dwordx4 v[20:23], v9, s[44:47], s60 offen sc1
  s_add_u32 s60, s60, 81920
  buffer_load_dwordx4 v[24:27], v9, s[44:47], s60 offen sc1
  s_add_u32 s60, s60, 81920
  buffer_load_dwordx4 v[28:31], v9, s[44:47], s60 offen sc1
  s_add_u32 s60, s60, 81920
  buffer_load_dwordx4 v[32:35], v9, s[44:47], s60 offen sc1
  s_add_u32 s60, s60, 81920
  buffer_load_dwordx4 v[36:39], v9, s[44:47], s60 offen sc1
  s_add_u32 s60, s60, 81920
  buffer_load_dwordx4 v[40:43], v9, s[44:47], s60 offen sc1
  s_add_u32 s60, s60, 81920
  buffer_load_dwordx4 v[44:47], v9, s[44:47], s60 offen sc1
  s_add_u32 s60, s60, 81920
  buffer_load_dwordx4 v[48:51], v9, s[44:47], s60 offen sc1
  s_add_u32 s60, s60, 81920
  buffer_load_dwordx4 v[52:55], v9, s[44:47], s60 offen sc1
  s_add_u32 s60, s60, 81920
  buffer_load_dwordx4 v[56:59], v9, s[44:47], s60 offen sc1
  s_add_u32 s60, s60, 81920
  buffer_load_dwordx4 v[60:63], v9, s[44:47], s60 offen sc1
  s_add_u32 s60, s60, 81920
  buffer_load_dwordx4 v[64:67], v9, s[44:47], s60 offen sc1
  s_add_u32 s60, s60, 81920
  s_mov_b64 exec, 0xffffffff
  buffer_load_dwordx4 v[68:71], v9, s[44:47], s60 offen sc1
  s_mov_b64 exec, -1
  s_mul_i32 s60, s65, 1280
  s_lshl_b32 s61, s84, 6
  s_add_u32 s60, s60, s61
  v_and_b32 v10, 15, v0
  v_lshlrev_b32 v10, 2, v10
  buffer_load_dword v12, v10, s[40:43], s60 offen
  s_waitcnt vmcnt(0)
  v_add_f32 v16, v16, v20
  v_add_f32 v17, v17, v21
  v_add_f32 v18, v18, v22
  v_add_f32 v19, v19, v23
  v_add_f32 v16, v16, v24
  v_add_f32 v17, v17, v25
  v_add_f32 v18, v18, v26
  v_add_f32 v19, v19, v27
  v_add_f32 v16, v16, v28
  v_add_f32 v17, v17, v29
  v_add_f32 v18, v18, v30
  v_add_f32 v19, v19, v31
  v_add_f32 v16, v16, v32
  v_add_f32 v17, v17, v33
  v_add_f32 v18, v18, v34
  v_add_f32 v19, v19, v35
  v_add_f32 v16, v16, v36
  v_add_f32 v17, v17, v37
  v_add_f32 v18, v18, v38
  v_add_f32 v19, v19, v39
  v_add_f32 v16, v16, v40
  v_add_f32 v17, v17, v41
  v_add_f32 v18, v18, v42
  v_add_f32 v19, v19, v43
  v_add_f32 v16, v16, v44
  v_add_f32 v17, v17, v45
  v_add_f32 v18, v18, v46
  v_add_f32 v19, v19, v47
  v_add_f32 v16, v16, v48
  v_add_f32 v17, v17, v49
  v_add_f32 v18, v18, v50
  v_add_f32 v19, v19, v51
  v_add_f32 v16, v16, v52
  v_add_f32 v17, v17, v53
  v_add_f32 v18, v18, v54
  v_add_f32 v19, v19, v55
  v_add_f32 v16, v16, v56
  v_add_f32 v17, v17, v57
  v_add_f32 v18, v18, v58
  v_add_f32 v19, v19, v59
  v_add_f32 v16, v16, v60
  v_add_f32 v17, v17, v61
  v_add_f32 v18, v18, v62
  v_add_f32 v19, v19, v63
  v_add_f32 v16, v16, v64
  v_add_f32 v17, v17, v65
  v_add_f32 v18, v18, v66
  v_add_f32 v19, v19, v67
  v_add_f32 v16, v16, v68
  v_add_f32 v17, v17, v69
  v_add_f32 v18, v18, v70
  v_add_f32 v19, v19, v71
  v_add_f32_dpp v16, v16, v16 row_ror:8 row_mask:0xf bank_mask:0xf
  v_mov_b32 v20, v16
  s_nop 1
  v_permlane16_swap_b32 v16, v20
  v_add_f32 v16, v16, v20
  v_mov_b32 v20, v16
  s_nop 1
  v_permlane32_swap_b32 v16, v20
  v_add_f32 v16, v16, v20
  v_add_f32_dpp v17, v17, v17 row_ror:8 row_mask:0xf bank_mask:0xf
  v_mov_b32 v20, v17
  s_nop 1
  v_permlane16_swap_b32 v17, v20
  v_add_f32 v17, v17, v20
  v_mov_b32 v20, v17
  s_nop 1
  v_permlane32_swap_b32 v17, v20
  v_add_f32 v17, v17, v20
  v_add_f32_dpp v18, v18, v18 row_ror:8 row_mask:0xf bank_mask:0xf
  v_mov_b32 v20, v18
  s_nop 1
  v_permlane16_swap_b32 v18, v20
  v_add_f32 v18, v18, v20
  v_mov_b32 v20, v18
  s_nop 1
  v_permlane32_swap_b32 v18, v20
  v_add_f32 v18, v18, v20
  v_add_f32_dpp v19, v19, v19 row_ror:8 row_mask:0xf bank_mask:0xf
  v_mov_b32 v20, v19
  s_nop 1
  v_permlane16_swap_b32 v19, v20
  v_add_f32 v19, v19, v20
  v_mov_b32 v20, v19
  s_nop 1
  v_permlane32_swap_b32 v19, v20
  v_add_f32 v19, v19, v20
  v_cvt_pk_bf16_f32 v16, v16, v16
  v_lshlrev_b32 v16, 16, v16
  v_mul_f32 v20, 0xbfb8aa3b, v16
  v_exp_f32 v20, v20
  s_nop 0
  v_add_f32 v20, 1.0, v20
  v_rcp_f32 v21, v20
  s_nop 0
  v_mul_f32 v22, v16, v21
  v_fma_f32 v23, -v22, v20, v16
  v_fma_f32 v23, v23, v21, v22
  v_cmp_u_f32 vcc, v23, v23
  s_nop 1
  v_cndmask_b32 v22, v23, v22, vcc
  v_cvt_pk_bf16_f32 v24, v22, v22
  v_lshlrev_b32 v24, 16, v24
  v_cvt_pk_bf16_f32 v17, v17, v17
  v_lshlrev_b32 v17, 16, v17
  v_mul_f32 v20, 0xbfb8aa3b, v17
  v_exp_f32 v20, v20
  s_nop 0
  v_add_f32 v20, 1.0, v20
  v_rcp_f32 v21, v20
  s_nop 0
  v_mul_f32 v22, v17, v21
  v_fma_f32 v23, -v22, v20, v17
  v_fma_f32 v23, v23, v21, v22
  v_cmp_u_f32 vcc, v23, v23
  s_nop 1
  v_cndmask_b32 v22, v23, v22, vcc
  v_cvt_pk_bf16_f32 v25, v22, v22
  v_lshlrev_b32 v25, 16, v25
  v_cvt_pk_bf16_f32 v18, v18, v18
  v_lshlrev_b32 v18, 16, v18
  v_mul_f32 v20, 0xbfb8aa3b, v18
  v_exp_f32 v20, v20
  s_nop 0
  v_add_f32 v20, 1.0, v20
  v_rcp_f32 v21, v20
  s_nop 0
  v_mul_f32 v22, v18, v21
  v_fma_f32 v23, -v22, v20, v18
  v_fma_f32 v23, v23, v21, v22
  v_cmp_u_f32 vcc, v23, v23
  s_nop 1
  v_cndmask_b32 v22, v23, v22, vcc
  v_cvt_pk_bf16_f32 v26, v22, v22
  v_lshlrev_b32 v26, 16, v26
  v_cvt_pk_bf16_f32 v19, v19, v19
  v_lshlrev_b32 v19, 16, v19
  v_mul_f32 v20, 0xbfb8aa3b, v19
  v_exp_f32 v20, v20
  s_nop 0
  v_add_f32 v20, 1.0, v20
  v_rcp_f32 v21, v20
  s_nop 0
  v_mul_f32 v22, v19, v21
  v_fma_f32 v23, -v22, v20, v19
  v_fma_f32 v23, v23, v21, v22
  v_cmp_u_f32 vcc, v23, v23
  s_nop 1
  v_cndmask_b32 v22, v23, v22, vcc
  v_cvt_pk_bf16_f32 v27, v22, v22
  v_lshlrev_b32 v27, 16, v27
  v_and_b32 v9, 7, v0
  v_lshlrev_b32 v9, 4, v9
  ds_write_b128 v9, v[24:27] offset:26368
  v_and_b32 v9, 15, v0
  v_lshlrev_b32 v9, 3, v9
  s_waitcnt lgkmcnt(0)
  ds_read_b64 v[88:89], v9 offset:26368
  v_lshlrev_b32 v92, 16, v12
  v_and_b32 v93, 0xffff0000, v12
  s_waitcnt lgkmcnt(0)
L_tail_94:
  v_lshrrev_b32 v9, 4, v0
  v_lshlrev_b32 v9, 7, v9
  s_lshl_b32 s60, s63, 5
  v_add_u32 v9, s60, v9
  v_lshrrev_b32 v10, 4, v0
  v_lshlrev_b32 v10, 7, v10
  v_and_b32 v11, 15, v0
  v_lshlrev_b32 v11, 2, v11
  v_add_u32 v10, v10, v11
  s_mul_i32 s60, s63, 2560
  v_add_u32 v10, s60, v10
  s_lshl_b32 s60, s63, 6
  v_add_u32 v76, s60, v0
  v_lshrrev_b32 v77, 3, v76
  v_lshlrev_b32 v77, 14, v77
  v_and_b32 v78, 7, v76
  v_lshlrev_b32 v78, 5, v78
  v_add_u32 v77, v77, v78
  v_lshlrev_b32 v78, 4, v76
  s_mul_i32 s62, s65, 327680
  s_lshl_b32 s69, s67, 8
  s_add_u32 s62, s62, s69
  s_waitcnt vmcnt(0)
  s_barrier
  ds_read_b128 v[16:19], v9 offset:14080
  ds_read_b128 v[24:27], v9 offset:14592
  ds_read_b128 v[32:35], v9 offset:15104
  ds_read_b128 v[40:43], v9 offset:15616
  ds_read_b128 v[20:23], v9 offset:14096
  ds_read_b128 v[28:31], v9 offset:14608
  ds_read_b128 v[36:39], v9 offset:15120
  ds_read_b128 v[44:47], v9 offset:15632
  s_waitcnt lgkmcnt(4)
  v_add_f32 v16, v16, v24
  v_add_f32 v32, v32, v40
  v_add_f32 v16, v16, v32
  v_cvt_pk_bf16_f32 v16, v16, v16
  v_add_f32 v17, v17, v25
  v_add_f32 v33, v33, v41
  v_add_f32 v17, v17, v33
  v_cvt_pk_bf16_f32 v17, v17, v17
  v_and_b32 v68, v16, v4
  v_and_b32 v69, v16, v5
  v_and_b32 v70, v16, v6
  v_and_b32 v71, v16, v7
  s_nop 1
  v_mfma_f32_16x16x32_bf16 v[48:51], v[96:99], v[68:71], 0
  v_and_b32 v72, v17, v4
  v_and_b32 v73, v17, v5
  v_mfma_f32_16x16x32_bf16 v[52:55], v[100:103], v[68:71], 0
  v_and_b32 v74, v17, v6
  v_and_b32 v75, v17, v7
  v_mfma_f32_16x16x32_bf16 v[56:59], v[104:107], v[68:71], 0
  v_add_f32 v18, v18, v26
  v_add_f32 v34, v34, v42
  v_mfma_f32_16x16x32_bf16 v[60:63], v[108:111], v[68:71], 0
  v_add_f32 v18, v18, v34
  v_cvt_pk_bf16_f32 v18, v18, v18
  v_mfma_f32_16x16x32_bf16 v[64:67], v[112:115], v[68:71], 0
  v_mfma_f32_16x16x32_bf16 v[48:51], v[116:119], v[72:75], v[48:51]
  v_and_b32 v68, v18, v4
  v_and_b32 v69, v18, v5
  v_mfma_f32_16x16x32_bf16 v[52:55], v[120:123], v[72:75], v[52:55]
  v_and_b32 v70, v18, v6
  v_and_b32 v71, v18, v7
  v_mfma_f32_16x16x32_bf16 v[56:59], v[124:127], v[72:75], v[56:59]
  v_add_f32 v19, v19, v27
  v_add_f32 v35, v35, v43
  v_mfma_f32_16x16x32_bf16 v[60:63], v[128:131], v[72:75], v[60:63]
  v_add_f32 v19, v19, v35
  v_cvt_pk_bf16_f32 v19, v19, v19
  v_mfma_f32_16x16x32_bf16 v[64:67], v[132:135], v[72:75], v[64:67]
  v_mfma_f32_16x16x32_bf16 v[48:51], v[136:139], v[68:71], v[48:51]
  s_waitcnt lgkmcnt(0)
  v_and_b32 v72, v19, v4
  v_and_b32 v73, v19, v5
  v_mfma_f32_16x16x32_bf16 v[52:55], v[140:143], v[68:71], v[52:55]
  v_and_b32 v74, v19, v6
  v_and_b32 v75, v19, v7
  v_mfma_f32_16x16x32_bf16 v[56:59], v[144:147], v[68:71], v[56:59]
  v_add_f32 v20, v20, v28
  v_add_f32 v36, v36, v44
  v_mfma_f32_16x16x32_bf16 v[60:63], v[148:151], v[68:71], v[60:63]
  v_add_f32 v20, v20, v36
  v_cvt_pk_bf16_f32 v20, v20, v20
  v_mfma_f32_16x16x32_bf16 v[64:67], v[152:155], v[68:71], v[64:67]
  v_mfma_f32_16x16x32_bf16 v[48:51], v[156:159], v[72:75], v[48:51]
  v_and_b32 v68, v20, v4
  v_and_b32 v69, v20, v5
  v_mfma_f32_16x16x32_bf16 v[52:55], v[160:163], v[72:75], v[52:55]
  v_and_b32 v70, v20, v6
  v_and_b32 v71, v20, v7
  v_mfma_f32_16x16x32_bf16 v[56:59], v[164:167], v[72:75], v[56:59]
  v_add_f32 v21, v21, v29
  v_add_f32 v37, v37, v45
  v_mfma_f32_16x16x32_bf16 v[60:63], v[168:171], v[72:75], v[60:63]
  v_add_f32 v21, v21, v37
  v_cvt_pk_bf16_f32 v21, v21, v21
  v_mfma_f32_16x16x32_bf16 v[64:67], v[172:175], v[72:75], v[64:67]
  v_mfma_f32_16x16x32_bf16 v[48:51], v[176:179], v[68:71], v[48:51]
  v_and_b32 v72, v21, v4
  v_and_b32 v73, v21, v5
  v_mfma_f32_16x16x32_bf16 v[52:55], v[180:183], v[68:71], v[52:55]
  v_and_b32 v74, v21, v6
  v_and_b32 v75, v21, v7
  v_mfma_f32_16x16x32_bf16 v[56:59], v[184:187], v[68:71], v[56:59]
  v_add_f32 v22, v22, v30
  v_add_f32 v38, v38, v46
  v_mfma_f32_16x16x32_bf16 v[60:63], v[188:191], v[68:71], v[60:63]
  v_add_f32 v22, v22, v38
  v_cvt_pk_bf16_f32 v22, v22, v22
  v_mfma_f32_16x16x32_bf16 v[64:67], v[192:195], v[68:71], v[64:67]
  v_mfma_f32_16x16x32_bf16 v[48:51], v[196:199], v[72:75], v[48:51]
  v_and_b32 v68, v22, v4
  v_and_b32 v69, v22, v5
  v_mfma_f32_16x16x32_bf16 v[52:55], v[200:203], v[72:75], v[52:55]
  v_and_b32 v70, v22, v6
  v_and_b32 v71, v22, v7
  v_mfma_f32_16x16x32_bf16 v[56:59], v[204:207], v[72:75], v[56:59]
  v_add_f32 v23, v23, v31
  v_add_f32 v39, v39, v47
  v_mfma_f32_16x16x32_bf16 v[60:63], v[208:211], v[72:75], v[60:63]
  v_add_f32 v23, v23, v39
  v_cvt_pk_bf16_f32 v23, v23, v23
  v_mfma_f32_16x16x32_bf16 v[64:67], v[212:215], v[72:75], v[64:67]
  v_mfma_f32_16x16x32_bf16 v[48:51], v[216:219], v[68:71], v[48:51]
  v_and_b32 v72, v23, v4
  v_and_b32 v73, v23, v5
  v_mfma_f32_16x16x32_bf16 v[52:55], v[220:223], v[68:71], v[52:55]
  v_and_b32 v74, v23, v6
  v_and_b32 v75, v23, v7
  v_mfma_f32_16x16x32_bf16 v[56:59], v[224:227], v[68:71], v[56:59]
  v_mfma_f32_16x16x32_bf16 v[60:63], v[228:231], v[68:71], v[60:63]
  v_mfma_f32_16x16x32_bf16 v[64:67], v[232:235], v[68:71], v[64:67]
  v_mfma_f32_16x16x32_bf16 v[48:51], v[236:239], v[72:75], v[48:51]
  v_mfma_f32_16x16x32_bf16 v[52:55], v[240:243], v[72:75], v[52:55]
  v_mfma_f32_16x16x32_bf16 v[56:59], v[244:247], v[72:75], v[56:59]
  v_mfma_f32_16x16x32_bf16 v[60:63], v[248:251], v[72:75], v[60:63]
  v_mfma_f32_16x16x32_bf16 v[64:67], v[252:255], v[72:75], v[64:67]
  s_mov_b32 exec_lo, 0x00ff00ff
  s_mov_b32 exec_hi, 0x00ff00ff
  s_nop 1
  ds_write_b32 v10, v48 offset:16128
  ds_write_b32 v10, v49 offset:16160
  ds_write_b32 v10, v50 offset:16192
  ds_write_b32 v10, v51 offset:16224
  ds_write_b32 v10, v52 offset:16640
  ds_write_b32 v10, v53 offset:16672
  ds_write_b32 v10, v54 offset:16704
  ds_write_b32 v10, v55 offset:16736
  ds_write_b32 v10, v56 offset:17152
  ds_write_b32 v10, v57 offset:17184
  ds_write_b32 v10, v58 offset:17216
  ds_write_b32 v10, v59 offset:17248
  ds_write_b32 v10, v60 offset:17664
  ds_write_b32 v10, v61 offset:17696
  ds_write_b32 v10, v62 offset:17728
  ds_write_b32 v10, v63 offset:17760
  ds_write_b32 v10, v64 offset:18176
  ds_write_b32 v10, v65 offset:18208
  ds_write_b32 v10, v66 offset:18240
  ds_write_b32 v10, v67 offset:18272
  s_mov_b64 exec, -1
  s_waitcnt lgkmcnt(0)
  s_barrier
  s_cmp_eq_u32 s63, 3
  s_cbranch_scc1 L_fin_105
  v_cmp_gt_u32 vcc, 160, v76
  s_nop 0
  s_and_saveexec_b64 s[60:61], vcc
  s_nop 1
  s_cbranch_execz L_done_106
  ds_read_b128 v[16:19], v78 offset:16128
  ds_read_b128 v[20:23], v78 offset:18688
  ds_read_b128 v[24:27], v78 offset:21248
  ds_read_b128 v[28:31], v78 offset:23808
  v_mov_b32 v33, s58
  v_mov_b32 v35, s58
  v_mov_b32 v37, s58
  v_mov_b32 v39, s58
  s_waitcnt lgkmcnt(0)
  v_add_f32 v16, v16, v20
  v_add_f32 v24, v24, v28
  v_add_f32 v17, v17, v21
  v_add_f32 v25, v25, v29
  v_add_f32 v18, v18, v22
  v_add_f32 v26, v26, v30
  v_add_f32 v19, v19, v23
  v_add_f32 v27, v27, v31
  v_add_f32 v32, v16, v24
  v_add_f32 v34, v17, v25
  v_add_f32 v36, v18, v26
  v_add_f32 v38, v19, v27
  buffer_store_dwordx4 v[32:35], v77, s[44:47], s62 offen sc1
  buffer_store_dwordx4 v[36:39], v77, s[44:47], s62 offen offset:16 sc1
L_done_106:
  s_endpgm
L_fin_105:
  s_cmp_ge_u32 s84, 20
  s_cbranch_scc1 L_nofin_107
  s_mul_i32 s60, s65, 20
  s_add_u32 s60, s60, s84
  s_lshl_b32 s60, s60, 14
  s_add_u32 s81, s60, 4096
  s_add_u32 s82, s60, 8192
  s_add_u32 s83, s60, 12288
  s_mov_b32 s80, s60
  v_lshlrev_b32 v9, 4, v0
  s_mov_b32 s48, s26
  s_and_b32 s49, s27, 0xffff
  s_mov_b32 s50, 0x1400
  s_mov_b32 s51, 0x20000
  s_mul_i32 s52, s65, 1280
  s_lshl_b32 s53, s84, 6
  s_add_u32 s52, s52, s53
  v_lshlrev_b32 v10, 2, v0
  buffer_load_dwordx4 v[16:19], v9, s[44:47], s80 offen offset:0 sc1
  buffer_load_dwordx4 v[20:23], v9, s[44:47], s80 offen offset:1024 sc1
  buffer_load_dwordx4 v[24:27], v9, s[44:47], s80 offen offset:2048 sc1
  buffer_load_dwordx4 v[28:31], v9, s[44:47], s80 offen offset:3072 sc1
  buffer_load_dwordx4 v[32:35], v9, s[44:47], s81 offen offset:0 sc1
  buffer_load_dwordx4 v[36:39], v9, s[44:47], s81 offen offset:1024 sc1
  buffer_load_dwordx4 v[40:43], v9, s[44:47], s81 offen offset:2048 sc1
  buffer_load_dwordx4 v[44:47], v9, s[44:47], s81 offen offset:3072 sc1
  buffer_load_dwordx4 v[48:51], v9, s[44:47], s82 offen offset:0 sc1
  buffer_load_dwordx4 v[52:55], v9, s[44:47], s82 offen offset:1024 sc1
  buffer_load_dwordx4 v[56:59], v9, s[44:47], s82 offen offset:2048 sc1
  buffer_load_dwordx4 v[60:63], v9, s[44:47], s82 offen offset:3072 sc1
  buffer_load_dwordx4 v[64:67], v9, s[44:47], s83 offen offset:0 sc1
  buffer_load_dwordx4 v[68:71], v9, s[44:47], s83 offen offset:1024 sc1
  buffer_load_dwordx4 v[72:75], v9, s[44:47], s83 offen offset:2048 sc1
  buffer_load_dwordx4 v[76:79], v9, s[44:47], s83 offen offset:3072 sc1
  s_mov_b32 s61, 0x100000
L_fp_108:
  s_waitcnt vmcnt(12)
  v_min_u32 v80, v17, v19
  v_max_u32 v81, v17, v19
  v_min3_u32 v80, v80, v21, v23
  v_max3_u32 v81, v81, v21, v23
  v_min3_u32 v80, v80, v25, v27
  v_max3_u32 v81, v81, v25, v27
  v_min3_u32 v80, v80, v29, v31
  v_max3_u32 v81, v81, v29, v31
  s_waitcnt vmcnt(8)
  v_min3_u32 v80, v80, v33, v35
  v_max3_u32 v81, v81, v33, v35
  v_min3_u32 v80, v80, v37, v39
  v_max3_u32 v81, v81, v37, v39
  v_min3_u32 v80, v80, v41, v43
  v_max3_u32 v81, v81, v41, v43
  v_min3_u32 v80, v80, v45, v47
  v_max3_u32 v81, v81, v45, v47
  s_waitcnt vmcnt(4)
  v_min3_u32 v80, v80, v49, v51
  v_max3_u32 v81, v81, v49, v51
  v_min3_u32 v80, v80, v53, v55
  v_max3_u32 v81, v81, v53, v55
  v_min3_u32 v80, v80, v57, v59
  v_max3_u32 v81, v81, v57, v59
  v_min3_u32 v80, v80, v61, v63
  v_max3_u32 v81, v81, v61, v63
  s_waitcnt vmcnt(0)
  v_min3_u32 v80, v80, v65, v67
  v_max3_u32 v81, v81, v65, v67
  v_min3_u32 v80, v80, v69, v71
  v_max3_u32 v81, v81, v69, v71
  v_min3_u32 v80, v80, v73, v75
  v_max3_u32 v81, v81, v73, v75
  v_min3_u32 v80, v80, v77, v79
  v_max3_u32 v81, v81, v77, v79
  v_cmp_ne_u32 vcc, s58, v80
  v_cmp_ne_u32 s[76:77], s58, v81
  s_nop 0
  s_or_b64 vcc, vcc, s[76:77]
  s_nop 1
  s_cbranch_vccz L_fpd_109
  buffer_load_dwordx4 v[16:19], v9, s[44:47], s80 offen offset:0 sc1
  buffer_load_dwordx4 v[20:23], v9, s[44:47], s80 offen offset:1024 sc1
  buffer_load_dwordx4 v[24:27], v9, s[44:47], s80 offen offset:2048 sc1
  buffer_load_dwordx4 v[28:31], v9, s[44:47], s80 offen offset:3072 sc1
  buffer_load_dwordx4 v[32:35], v9, s[44:47], s81 offen offset:0 sc1
  buffer_load_dwordx4 v[36:39], v9, s[44:47], s81 offen offset:1024 sc1
  buffer_load_dwordx4 v[40:43], v9, s[44:47], s81 offen offset:2048 sc1
  buffer_load_dwordx4 v[44:47], v9, s[44:47], s81 offen offset:3072 sc1
  buffer_load_dwordx4 v[48:51], v9, s[44:47], s82 offen offset:0 sc1
  buffer_load_dwordx4 v[52:55], v9, s[44:47], s82 offen offset:1024 sc1
  buffer_load_dwordx4 v[56:59], v9, s[44:47], s82 offen offset:2048 sc1
  buffer_load_dwordx4 v[60:63], v9, s[44:47], s82 offen offset:3072 sc1
  buffer_load_dwordx4 v[64:67], v9, s[44:47], s83 offen offset:0 sc1
  buffer_load_dwordx4 v[68:71], v9, s[44:47], s83 offen offset:1024 sc1
  buffer_load_dwordx4 v[72:75], v9, s[44:47], s83 offen offset:2048 sc1
  buffer_load_dwordx4 v[76:79], v9, s[44:47], s83 offen offset:3072 sc1
  s_sub_u32 s61, s61, 1
  s_cmp_lg_u32 s61, 0
  s_cbranch_scc1 L_fp_108
  s_waitcnt vmcnt(0)
L_fpd_109:
  v_add_f32 v16, v16, v20
  v_add_f32 v18, v18, v22
  v_add_f32 v24, v24, v28
  v_add_f32 v26, v26, v30
  v_add_f32 v32, v32, v36
  v_add_f32 v34, v34, v38
  v_add_f32 v40, v40, v44
  v_add_f32 v42, v42, v46
  v_add_f32 v48, v48, v52
  v_add_f32 v50, v50, v54
  v_add_f32 v56, v56, v60
  v_add_f32 v58, v58, v62
  v_add_f32 v64, v64, v68
  v_add_f32 v66, v66, v70
  v_add_f32 v72, v72, v76
  v_add_f32 v74, v74, v78
  v_add_f32 v16, v16, v24
  v_add_f32 v18, v18, v26
  v_add_f32 v32, v32, v40
  v_add_f32 v34, v34, v42
  v_add_f32 v48, v48, v56
  v_add_f32 v50, v50, v58
  v_add_f32 v64, v64, v72
  v_add_f32 v66, v66, v74
  v_add_f32 v16, v16, v32
  v_add_f32 v18, v18, v34
  v_add_f32 v48, v48, v64
  v_add_f32 v50, v50, v66
  v_add_f32 v16, v16, v48
  v_add_f32 v18, v18, v50
  v_mov_b32 v20, v16
  v_mov_b32 v22, v18
  s_nop 0
  v_permlane16_swap_b32 v16, v20
  v_permlane16_swap_b32 v18, v22
  v_add_f32 v16, v16, v20
  v_add_f32 v18, v18, v22
  v_mov_b32 v20, v16
  v_mov_b32 v22, v18
  s_nop 0
  v_permlane32_swap_b32 v16, v20
  v_permlane32_swap_b32 v18, v22
  v_add_f32 v16, v16, v20
  v_add_f32 v18, v18, v22
  v_cvt_pk_bf16_f32 v16, v16, v18
  v_lshlrev_b32 v17, 16, v16
  v_and_b32 v18, 0xffff0000, v16
  v_mul_f32 v17, v17, v88
  v_mul_f32 v18, v18, v89
  v_cvt_pk_bf16_f32 v16, v17, v18
  v_lshlrev_b32 v17, 16, v16
  v_and_b32 v18, 0xffff0000, v16
  v_add_f32 v17, v17, v92
  v_add_f32 v18, v18, v93
  v_cvt_pk_bf16_f32 v16, v17, v18
  s_mov_b64 exec, 0xffff
  buffer_store_dword v16, v10, s[48:51], s52 offen
  s_mov_b64 exec, -1
  s_or_b32 s60, s65, s84
  s_cmp_lg_u32 s60, 0
  s_cbranch_scc1 L_nofin_107
  v_mov_b32 v9, 0
  v_mov_b32 v11, s58
  s_mov_b32 s60, 0x148000
  s_mov_b64 exec, 1
  buffer_store_dword v11, v9, s[44:47], s60 offen sc1
  s_mov_b64 exec, -1
L_nofin_107:
L_end:
  s_endpgm
.section .rodata,"a"
.p2align 6
.amdhsa_kernel recurrent_scan__gqa_block_cached__geglu_ffn__decode_kernel
  .amdhsa_next_free_vgpr 256
  .amdhsa_next_free_sgpr 102
  .amdhsa_accum_offset 256
  .amdhsa_group_segment_fixed_size 0
  .amdhsa_kernarg_size 96
  .amdhsa_user_sgpr_count 2
  .amdhsa_user_sgpr_kernarg_segment_ptr 1
  .amdhsa_system_sgpr_workgroup_id_x 1
  .amdhsa_float_denorm_mode_32 3
.end_amdhsa_kernel
```
